```python
import torch

def _softmax(x, axis=-1):
    return torch.softmax(x, dim=axis)
def _gelu(x):
    return torch.nn.functional.gelu(x, approximate="tanh")
def _silu(x):
    return torch.nn.functional.silu(x)
def _sigmoid(x):
    return torch.sigmoid(x)
def _layernorm(x, axis=-1, eps=1e-5):
    m = x.mean(dim=axis, keepdim=True)
    v = x.var(dim=axis, keepdim=True, unbiased=False)
    return (x - m) / torch.sqrt(v + eps)
def _scatter_add(tgt, idx, src, axis=0):
    return tgt.clone().index_add_(axis, idx, src)
def _segment_sum(src, seg, n):
    out = torch.zeros((n,) + src.shape[1:], dtype=src.dtype)
    return out.index_add_(0, seg, src)
def _pad(x, pw):
    flat = tuple(v for pair in reversed(pw) for v in pair)
    return torch.nn.functional.pad(x, flat)

kernel_name = 'sequential_preLN__softmax_full_mha__geglu_ffn__prompt'

def setup_inputs():

    _w = (lambda a: (lambda t: t.to(torch.bfloat16) if t.is_floating_point() else t)(torch.as_tensor(a)))
    def _A_setup():
        B, S, D = 1, 2048, 640
        return {
            "x": _w((lambda *s: torch.randn(*s, dtype=torch.bfloat16) * 0.05)(B, S, D)),
            "wqkv": _w((lambda *s: torch.randn(*s, dtype=torch.bfloat16) * 0.05)(D, 3 * D)),
            "wo": _w((lambda *s: torch.randn(*s, dtype=torch.bfloat16) * 0.05)(D, D)),
        }
    _A_in = _A_setup()

    def _B_setup():
        B, S, D, F = 1, 2048, 640, 1536
        return {
            "x": _w((lambda *s: torch.randn(*s, dtype=torch.bfloat16) * 0.05)(B, S, D)),
            "w_gate": _w((lambda *s: torch.randn(*s, dtype=torch.bfloat16) * 0.05)(D, F)),
            "w_up": _w((lambda *s: torch.randn(*s, dtype=torch.bfloat16) * 0.05)(D, F)),
            "w_down": _w((lambda *s: torch.randn(*s, dtype=torch.bfloat16) * 0.05)(F, D)),
        }
    _B_in = _B_setup()

    return {
        "A_x": _A_in["x"],
        "A_wqkv": _A_in["wqkv"],
        "A_wo": _A_in["wo"],
        "B_x": _B_in["x"],
        "B_w_gate": _B_in["w_gate"],
        "B_w_up": _B_in["w_up"],
        "B_w_down": _B_in["w_down"],
    }

def reference(A_x, A_wqkv, A_wo, B_x, B_w_gate, B_w_up, B_w_down):
    def _A_ref(x, wqkv, wo):
        B, S, D = x.shape
        H = 32; Dh = D // H
        qkv = (lambda x, *d: x.permute(*d))((x @ wqkv).reshape(B, S, 3, H, Dh), 2, 0, 3, 1, 4)
        q, k, v = qkv[0], qkv[1], qkv[2]
        scale = Dh ** -0.5
        scores = torch.einsum("bhqd,bhkd->bhqk", q, k) * scale
        p = _softmax(scores, axis=-1)
        o = torch.einsum("bhqk,bhkd->bhqd", p, v)
        return (lambda x, *d: x.permute(*d))(o, 0, 2, 1, 3).reshape(B, S, D) @ wo

    def _B_ref(x, w_gate, w_up, w_down):
        return (_gelu(x @ w_gate) * (x @ w_up)) @ w_down

    x = A_x
    h = x + _A_ref(_layernorm(x, axis=-1), A_wqkv, A_wo)
    h2 = h + _B_ref(_layernorm(h, axis=-1), B_w_gate, B_w_up, B_w_down)
    return h2
```

```asm
; @launch kernel=qkv_kernel grid=(256,1,1) block=(512,1,1) lds=133120
; @launch kernel=mega_kernel grid=(256,1,1) block=(512,1,1) lds=163840
.amdgcn_target "amdgcn-amd-amdhsa--gfx950"
.text
.globl qkv_kernel
.p2align 8
.type qkv_kernel,@function
qkv_kernel:
    s_cmp_ge_u32 s2, 256
    s_cbranch_scc1 K1_end
    s_load_dwordx4 s[4:7], s[0:1], 0
    s_load_dwordx2 s[8:9], s[0:1], 72
    s_load_dwordx4 s[12:15], s[0:1], 32
    v_lshrrev_b32 v1, 6, v0
    v_and_b32 v0, 63, v0
    s_and_b32 s3, s2, 7
    v_readfirstlane_b32 s45, v1
    s_lshr_b32 s10, s2, 3
    s_lshr_b32 s29, s3, 1
    s_lshl_b32 s29, s29, 2
    s_and_b32 s11, s10, 3
    s_add_u32 s29, s29, s11
    s_and_b32 s30, s3, 1
    s_lshl_b32 s30, s30, 3
    s_lshr_b32 s10, s10, 2
    s_add_u32 s30, s30, s10
    s_and_b32 s28, s45, 3
    s_lshl_b32 s11, s11, 1
    s_add_u32 s10, s10, s11
    s_lshl_b32 s10, s10, 1
    s_lshr_b32 s11, s3, 1
    s_add_u32 s10, s10, s11
    s_mul_i32 s10, s10, 5
    s_lshr_b32 s44, s10, 3
    s_cmp_ge_u32 s44, 10
    s_cselect_b32 s10, 10, 0
    s_sub_u32 s44, s44, s10
    v_lshrrev_b32 v1, 3, v0
    s_lshl_b32 s10, s28, 5
    v_add_u32 v1, s10, v1
    v_mul_u32_u24 v1, 1280, v1
    v_and_b32 v2, 7, v0
    v_lshrrev_b32 v3, 4, v0
    v_xor_b32 v2, v2, v3
    v_lshl_add_u32 v8, v2, 4, v1
    v_xor_b32 v9, 64, v8
    v_add_u32 v9, 10240, v9
    v_add_u32 v10, 20480, v8
    v_add_u32 v11, 20480, v9
    s_lshl_b32 s10, s28, 4
    v_add_u32 v1, s10, v3
    v_mul_u32_u24 v1, 3840, v1
    v_and_b32 v2, 15, v0
    v_lshlrev_b32 v4, 2, v3
    v_xor_b32 v2, v2, v4
    v_lshl_add_u32 v12, v2, 4, v1
    v_add_u32 v13, 15360, v12
    v_add_u32 v14, 30720, v12
    v_add_u32 v15, 46080, v12
    s_mul_i32 s42, s29, 163840
    s_lshl_b32 s43, s30, 8
    s_lshl_b32 s33, s28, 12
    s_mov_b32 s36, 0x3f803f80
    s_mov_b32 s46, 819200
    s_mov_b32 s18, 2621440
    s_mov_b32 s19, 0x00020000
    s_mov_b32 s22, 2457600
    s_mov_b32 s23, 0x00020000
    s_mov_b32 s26, 34603008
    s_mov_b32 s27, 0x00020000
    s_waitcnt lgkmcnt(0)
    s_mov_b32 s16, s4
    s_and_b32 s17, s5, 0xffff
    s_mov_b32 s20, s6
    s_and_b32 s21, s7, 0xffff
    s_mov_b32 s24, s8
    s_and_b32 s25, s9, 0xffff
    s_cmp_eq_u32 s30, 15
    s_cbranch_scc1 K1_spare
    s_cmp_lt_u32 s45, 4
    s_cbranch_scc1 K1_comp
    s_lshl_b32 s31, s44, 7
    s_add_u32 s31, s31, s42
    s_mul_i32 s32, s44, 245760
    s_add_u32 s32, s32, s43
    s_add_u32 m0, s33, 0
    s_nop 0
    buffer_load_dwordx4 v8, s[16:19], s31 offen lds
    s_add_u32 m0, s33, 16384
    s_nop 0
    buffer_load_dwordx4 v12, s[20:23], s32 offen lds
    s_add_u32 m0, s33, 1024
    s_nop 0
    buffer_load_dwordx4 v9, s[16:19], s31 offen lds
    s_add_u32 m0, s33, 17408
    s_nop 0
    buffer_load_dwordx4 v13, s[20:23], s32 offen lds
    s_add_u32 m0, s33, 2048
    s_nop 0
    buffer_load_dwordx4 v10, s[16:19], s31 offen lds
    s_add_u32 m0, s33, 18432
    s_nop 0
    buffer_load_dwordx4 v14, s[20:23], s32 offen lds
    s_add_u32 m0, s33, 3072
    s_nop 0
    buffer_load_dwordx4 v11, s[16:19], s31 offen lds
    s_add_u32 m0, s33, 19456
    s_nop 0
    buffer_load_dwordx4 v15, s[20:23], s32 offen lds
    s_add_u32 s44, s44, 1
    s_cmp_eq_u32 s44, 10
    s_cselect_b32 s44, 0, s44
    s_lshl_b32 s31, s44, 7
    s_add_u32 s31, s31, s42
    s_mul_i32 s32, s44, 245760
    s_add_u32 s32, s32, s43
    s_add_u32 m0, s33, 32768
    s_nop 0
    buffer_load_dwordx4 v8, s[16:19], s31 offen lds
    s_add_u32 m0, s33, 49152
    s_nop 0
    buffer_load_dwordx4 v12, s[20:23], s32 offen lds
    s_add_u32 m0, s33, 33792
    s_nop 0
    buffer_load_dwordx4 v9, s[16:19], s31 offen lds
    s_add_u32 m0, s33, 50176
    s_nop 0
    buffer_load_dwordx4 v13, s[20:23], s32 offen lds
    s_add_u32 m0, s33, 34816
    s_nop 0
    buffer_load_dwordx4 v10, s[16:19], s31 offen lds
    s_add_u32 m0, s33, 51200
    s_nop 0
    buffer_load_dwordx4 v14, s[20:23], s32 offen lds
    s_add_u32 m0, s33, 35840
    s_nop 0
    buffer_load_dwordx4 v11, s[16:19], s31 offen lds
    s_add_u32 m0, s33, 52224
    s_nop 0
    buffer_load_dwordx4 v15, s[20:23], s32 offen lds
    s_add_u32 s44, s44, 1
    s_cmp_eq_u32 s44, 10
    s_cselect_b32 s44, 0, s44
    s_waitcnt vmcnt(8)
    s_barrier
    s_lshl_b32 s31, s44, 7
    s_add_u32 s31, s31, s42
    s_mul_i32 s32, s44, 245760
    s_add_u32 s32, s32, s43
    s_add_u32 m0, s33, 65536
    s_nop 0
    buffer_load_dwordx4 v8, s[16:19], s31 offen lds
    s_add_u32 m0, s33, 81920
    s_nop 0
    buffer_load_dwordx4 v12, s[20:23], s32 offen lds
    s_add_u32 m0, s33, 66560
    s_nop 0
    buffer_load_dwordx4 v9, s[16:19], s31 offen lds
    s_add_u32 m0, s33, 82944
    s_nop 0
    buffer_load_dwordx4 v13, s[20:23], s32 offen lds
    s_add_u32 m0, s33, 67584
    s_nop 0
    buffer_load_dwordx4 v10, s[16:19], s31 offen lds
    s_add_u32 m0, s33, 83968
    s_nop 0
    buffer_load_dwordx4 v14, s[20:23], s32 offen lds
    s_add_u32 m0, s33, 68608
    s_nop 0
    buffer_load_dwordx4 v11, s[16:19], s31 offen lds
    s_add_u32 m0, s33, 84992
    s_nop 0
    buffer_load_dwordx4 v15, s[20:23], s32 offen lds
    s_add_u32 s44, s44, 1
    s_cmp_eq_u32 s44, 10
    s_cselect_b32 s44, 0, s44
    s_lshl_b32 s31, s44, 7
    s_add_u32 s31, s31, s42
    s_mul_i32 s32, s44, 245760
    s_add_u32 s32, s32, s43
    s_add_u32 m0, s33, 98304
    s_nop 0
    buffer_load_dwordx4 v8, s[16:19], s31 offen lds
    s_add_u32 m0, s33, 114688
    s_nop 0
    buffer_load_dwordx4 v12, s[20:23], s32 offen lds
    s_add_u32 m0, s33, 99328
    s_nop 0
    buffer_load_dwordx4 v9, s[16:19], s31 offen lds
    s_add_u32 m0, s33, 115712
    s_nop 0
    buffer_load_dwordx4 v13, s[20:23], s32 offen lds
    s_add_u32 m0, s33, 100352
    s_nop 0
    buffer_load_dwordx4 v10, s[16:19], s31 offen lds
    s_add_u32 m0, s33, 116736
    s_nop 0
    buffer_load_dwordx4 v14, s[20:23], s32 offen lds
    s_add_u32 m0, s33, 101376
    s_nop 0
    buffer_load_dwordx4 v11, s[16:19], s31 offen lds
    s_add_u32 m0, s33, 117760
    s_nop 0
    buffer_load_dwordx4 v15, s[20:23], s32 offen lds
    s_add_u32 s44, s44, 1
    s_cmp_eq_u32 s44, 10
    s_cselect_b32 s44, 0, s44
    s_waitcnt vmcnt(16)
    s_barrier
    s_lshl_b32 s31, s44, 7
    s_add_u32 s31, s31, s42
    s_mul_i32 s32, s44, 245760
    s_add_u32 s32, s32, s43
    s_add_u32 m0, s33, 0
    s_nop 0
    buffer_load_dwordx4 v8, s[16:19], s31 offen lds
    s_add_u32 m0, s33, 16384
    s_nop 0
    buffer_load_dwordx4 v12, s[20:23], s32 offen lds
    s_add_u32 m0, s33, 1024
    s_nop 0
    buffer_load_dwordx4 v9, s[16:19], s31 offen lds
    s_add_u32 m0, s33, 17408
    s_nop 0
    buffer_load_dwordx4 v13, s[20:23], s32 offen lds
    s_add_u32 m0, s33, 2048
    s_nop 0
    buffer_load_dwordx4 v10, s[16:19], s31 offen lds
    s_add_u32 m0, s33, 18432
    s_nop 0
    buffer_load_dwordx4 v14, s[20:23], s32 offen lds
    s_add_u32 m0, s33, 3072
    s_nop 0
    buffer_load_dwordx4 v11, s[16:19], s31 offen lds
    s_add_u32 m0, s33, 19456
    s_nop 0
    buffer_load_dwordx4 v15, s[20:23], s32 offen lds
    s_add_u32 s44, s44, 1
    s_cmp_eq_u32 s44, 10
    s_cselect_b32 s44, 0, s44
    s_waitcnt vmcnt(16)
    s_barrier
    s_lshl_b32 s31, s44, 7
    s_add_u32 s31, s31, s42
    s_mul_i32 s32, s44, 245760
    s_add_u32 s32, s32, s43
    s_add_u32 m0, s33, 32768
    s_nop 0
    buffer_load_dwordx4 v8, s[16:19], s31 offen lds
    s_add_u32 m0, s33, 49152
    s_nop 0
    buffer_load_dwordx4 v12, s[20:23], s32 offen lds
    s_add_u32 m0, s33, 33792
    s_nop 0
    buffer_load_dwordx4 v9, s[16:19], s31 offen lds
    s_add_u32 m0, s33, 50176
    s_nop 0
    buffer_load_dwordx4 v13, s[20:23], s32 offen lds
    s_add_u32 m0, s33, 34816
    s_nop 0
    buffer_load_dwordx4 v10, s[16:19], s31 offen lds
    s_add_u32 m0, s33, 51200
    s_nop 0
    buffer_load_dwordx4 v14, s[20:23], s32 offen lds
    s_add_u32 m0, s33, 35840
    s_nop 0
    buffer_load_dwordx4 v11, s[16:19], s31 offen lds
    s_add_u32 m0, s33, 52224
    s_nop 0
    buffer_load_dwordx4 v15, s[20:23], s32 offen lds
    s_add_u32 s44, s44, 1
    s_cmp_eq_u32 s44, 10
    s_cselect_b32 s44, 0, s44
    s_waitcnt vmcnt(16)
    s_barrier
    s_lshl_b32 s31, s44, 7
    s_add_u32 s31, s31, s42
    s_mul_i32 s32, s44, 245760
    s_add_u32 s32, s32, s43
    s_add_u32 m0, s33, 65536
    s_nop 0
    buffer_load_dwordx4 v8, s[16:19], s31 offen lds
    s_add_u32 m0, s33, 81920
    s_nop 0
    buffer_load_dwordx4 v12, s[20:23], s32 offen lds
    s_add_u32 m0, s33, 66560
    s_nop 0
    buffer_load_dwordx4 v9, s[16:19], s31 offen lds
    s_add_u32 m0, s33, 82944
    s_nop 0
    buffer_load_dwordx4 v13, s[20:23], s32 offen lds
    s_add_u32 m0, s33, 67584
    s_nop 0
    buffer_load_dwordx4 v10, s[16:19], s31 offen lds
    s_add_u32 m0, s33, 83968
    s_nop 0
    buffer_load_dwordx4 v14, s[20:23], s32 offen lds
    s_add_u32 m0, s33, 68608
    s_nop 0
    buffer_load_dwordx4 v11, s[16:19], s31 offen lds
    s_add_u32 m0, s33, 84992
    s_nop 0
    buffer_load_dwordx4 v15, s[20:23], s32 offen lds
    s_add_u32 s44, s44, 1
    s_cmp_eq_u32 s44, 10
    s_cselect_b32 s44, 0, s44
    s_waitcnt vmcnt(16)
    s_barrier
    s_lshl_b32 s31, s44, 7
    s_add_u32 s31, s31, s42
    s_mul_i32 s32, s44, 245760
    s_add_u32 s32, s32, s43
    s_add_u32 m0, s33, 98304
    s_nop 0
    buffer_load_dwordx4 v8, s[16:19], s31 offen lds
    s_add_u32 m0, s33, 114688
    s_nop 0
    buffer_load_dwordx4 v12, s[20:23], s32 offen lds
    s_add_u32 m0, s33, 99328
    s_nop 0
    buffer_load_dwordx4 v9, s[16:19], s31 offen lds
    s_add_u32 m0, s33, 115712
    s_nop 0
    buffer_load_dwordx4 v13, s[20:23], s32 offen lds
    s_add_u32 m0, s33, 100352
    s_nop 0
    buffer_load_dwordx4 v10, s[16:19], s31 offen lds
    s_add_u32 m0, s33, 116736
    s_nop 0
    buffer_load_dwordx4 v14, s[20:23], s32 offen lds
    s_add_u32 m0, s33, 101376
    s_nop 0
    buffer_load_dwordx4 v11, s[16:19], s31 offen lds
    s_add_u32 m0, s33, 117760
    s_nop 0
    buffer_load_dwordx4 v15, s[20:23], s32 offen lds
    s_add_u32 s44, s44, 1
    s_cmp_eq_u32 s44, 10
    s_cselect_b32 s44, 0, s44
    s_waitcnt vmcnt(16)
    s_barrier
    s_lshl_b32 s31, s44, 7
    s_add_u32 s31, s31, s42
    s_mul_i32 s32, s44, 245760
    s_add_u32 s32, s32, s43
    s_add_u32 m0, s33, 0
    s_nop 0
    buffer_load_dwordx4 v8, s[16:19], s31 offen lds
    s_add_u32 m0, s33, 16384
    s_nop 0
    buffer_load_dwordx4 v12, s[20:23], s32 offen lds
    s_add_u32 m0, s33, 1024
    s_nop 0
    buffer_load_dwordx4 v9, s[16:19], s31 offen lds
    s_add_u32 m0, s33, 17408
    s_nop 0
    buffer_load_dwordx4 v13, s[20:23], s32 offen lds
    s_add_u32 m0, s33, 2048
    s_nop 0
    buffer_load_dwordx4 v10, s[16:19], s31 offen lds
    s_add_u32 m0, s33, 18432
    s_nop 0
    buffer_load_dwordx4 v14, s[20:23], s32 offen lds
    s_add_u32 m0, s33, 3072
    s_nop 0
    buffer_load_dwordx4 v11, s[16:19], s31 offen lds
    s_add_u32 m0, s33, 19456
    s_nop 0
    buffer_load_dwordx4 v15, s[20:23], s32 offen lds
    s_add_u32 s44, s44, 1
    s_cmp_eq_u32 s44, 10
    s_cselect_b32 s44, 0, s44
    s_waitcnt vmcnt(16)
    s_barrier
    s_lshl_b32 s31, s44, 7
    s_add_u32 s31, s31, s42
    s_mul_i32 s32, s44, 245760
    s_add_u32 s32, s32, s43
    s_add_u32 m0, s33, 32768
    s_nop 0
    buffer_load_dwordx4 v8, s[16:19], s31 offen lds
    s_add_u32 m0, s33, 49152
    s_nop 0
    buffer_load_dwordx4 v12, s[20:23], s32 offen lds
    s_add_u32 m0, s33, 33792
    s_nop 0
    buffer_load_dwordx4 v9, s[16:19], s31 offen lds
    s_add_u32 m0, s33, 50176
    s_nop 0
    buffer_load_dwordx4 v13, s[20:23], s32 offen lds
    s_add_u32 m0, s33, 34816
    s_nop 0
    buffer_load_dwordx4 v10, s[16:19], s31 offen lds
    s_add_u32 m0, s33, 51200
    s_nop 0
    buffer_load_dwordx4 v14, s[20:23], s32 offen lds
    s_add_u32 m0, s33, 35840
    s_nop 0
    buffer_load_dwordx4 v11, s[16:19], s31 offen lds
    s_add_u32 m0, s33, 52224
    s_nop 0
    buffer_load_dwordx4 v15, s[20:23], s32 offen lds
    s_add_u32 s44, s44, 1
    s_cmp_eq_u32 s44, 10
    s_cselect_b32 s44, 0, s44
    s_waitcnt vmcnt(16)
    s_barrier
    s_load_dwordx2 s[4:5], s[0:1], 64
    s_waitcnt vmcnt(8)
    s_barrier
    s_cmp_eq_u32 s28, 3
    s_cbranch_scc1 K1_xs
    s_waitcnt vmcnt(0)
    s_barrier
    s_endpgm
K1_xs:
    s_waitcnt lgkmcnt(0)
    s_mov_b32 s16, s4
    s_and_b32 s17, s5, 0xffff
    s_mov_b32 s18, 256
    s_mov_b32 s19, 0x00020000
    s_lshl_b32 s10, s29, 2
    v_mov_b32 v1, 0
    buffer_load_dword v2, v1, s[16:19], s10 offen sc1
    s_mov_b32 s11, 0
    s_waitcnt vmcnt(0)
    s_barrier
K1_xp:
    v_readfirstlane_b32 s34, v2
    s_add_u32 s11, s11, 1
    s_cmp_lg_u32 s34, 0
    s_cbranch_scc1 K1_xg
    s_cmp_ge_u32 s11, 0x8000
    s_cbranch_scc1 K1_xg
    buffer_load_dword v2, v1, s[16:19], s10 offen sc1
    s_waitcnt vmcnt(0)
    s_branch K1_xp
K1_xg:
    s_lshl_b32 s10, s29, 10
    s_add_u32 s10, s10, 19922944
    v_lshlrev_b32 v1, 4, v0
    s_mov_b32 m0, 131584
    s_nop 0
    buffer_load_dwordx4 v1, s[24:27], s10 offen sc1 lds
    s_barrier
    s_waitcnt vmcnt(0)
    s_barrier
    s_endpgm
K1_comp:
    s_lshr_b32 s10, s2, 3
    s_lshl_b32 s11, s45, 5
    s_or_b32 s10, s10, s11
    s_cmp_ge_u32 s10, 5
    s_cbranch_scc1 K1_noct
    s_getpc_b64 s[48:49]
CT_1:
    s_sub_u32 s48, s48, CT_1-qkv_kernel
    s_subb_u32 s49, s49, 0
    s_and_b32 s49, s49, 0xffff
    s_mov_b32 s50, CODE_END-qkv_kernel
    s_mov_b32 s51, 0x00020000
    s_lshl_b32 s10, s10, 13
    v_lshlrev_b32 v1, 7, v0
    v_add_u32 v1, s10, v1
    buffer_load_dword v30, v1, s[48:51], 0 offen
K1_noct:
    v_and_b32 v1, 31, v0
    s_lshl_b32 s10, s28, 5
    v_add_u32 v2, s10, v1
    v_lshlrev_b32 v2, 7, v2
    v_lshrrev_b32 v3, 1, v1
    v_and_b32 v3, 7, v3
    v_lshrrev_b32 v4, 5, v0
    v_xor_b32 v3, v3, v4
    v_lshl_add_u32 v16, v3, 4, v2
    v_xor_b32 v17, 32, v16
    v_xor_b32 v18, 64, v16
    v_xor_b32 v19, 96, v16
    v_and_b32 v1, 15, v0
    v_lshrrev_b32 v2, 2, v1
    v_lshl_add_u32 v3, v4, 3, v2
    v_lshlrev_b32 v3, 8, v3
    v_add_u32 v3, 16384, v3
    v_lshrrev_b32 v5, 4, v0
    v_and_b32 v5, 1, v5
    v_lshl_add_u32 v3, v5, 5, v3
    v_and_b32 v5, 3, v1
    v_lshl_add_u32 v3, v5, 3, v3
    s_add_u32 s10, s28, 0
    s_and_b32 s10, s10, 3
    v_xor_b32 v5, s10, v2
    v_lshl_add_u32 v20, v5, 6, v3
    s_add_u32 s10, s28, 1
    s_and_b32 s10, s10, 3
    v_xor_b32 v5, s10, v2
    v_lshl_add_u32 v21, v5, 6, v3
    s_add_u32 s10, s28, 2
    s_and_b32 s10, s10, 3
    v_xor_b32 v5, s10, v2
    v_lshl_add_u32 v22, v5, 6, v3
    s_add_u32 s10, s28, 3
    s_and_b32 s10, s10, 3
    v_xor_b32 v5, s10, v2
    v_lshl_add_u32 v23, v5, 6, v3
    v_mov_b32 v24, 0
    v_mov_b32 v25, 0
    v_mov_b32 v26, 0
    v_mov_b32 v27, 0
    v_mov_b32 v28, 0
    v_mov_b32 v29, 0
    v_mov_b32 v72, 0
    v_mov_b32 v73, 0
    v_mov_b32 v74, 0
    v_mov_b32 v75, 0
    v_mov_b32 v76, 0
    v_mov_b32 v77, 0
    v_mov_b32 v78, 0
    v_mov_b32 v79, 0
    v_mov_b32 v80, 0
    v_mov_b32 v81, 0
    v_mov_b32 v82, 0
    v_mov_b32 v83, 0
    v_mov_b32 v84, 0
    v_mov_b32 v85, 0
    v_mov_b32 v86, 0
    v_mov_b32 v87, 0
    v_mov_b32 v88, 0
    v_mov_b32 v89, 0
    v_mov_b32 v90, 0
    v_mov_b32 v91, 0
    v_mov_b32 v92, 0
    v_mov_b32 v93, 0
    v_mov_b32 v94, 0
    v_mov_b32 v95, 0
    v_mov_b32 v96, 0
    v_mov_b32 v97, 0
    v_mov_b32 v98, 0
    v_mov_b32 v99, 0
    v_mov_b32 v100, 0
    v_mov_b32 v101, 0
    v_mov_b32 v102, 0
    v_mov_b32 v103, 0
    v_mov_b32 v104, 0
    v_mov_b32 v105, 0
    v_mov_b32 v106, 0
    v_mov_b32 v107, 0
    v_mov_b32 v108, 0
    v_mov_b32 v109, 0
    v_mov_b32 v110, 0
    v_mov_b32 v111, 0
    v_mov_b32 v112, 0
    v_mov_b32 v113, 0
    v_mov_b32 v114, 0
    v_mov_b32 v115, 0
    v_mov_b32 v116, 0
    v_mov_b32 v117, 0
    v_mov_b32 v118, 0
    v_mov_b32 v119, 0
    v_mov_b32 v120, 0
    v_mov_b32 v121, 0
    v_mov_b32 v122, 0
    v_mov_b32 v123, 0
    v_mov_b32 v124, 0
    v_mov_b32 v125, 0
    v_mov_b32 v126, 0
    v_mov_b32 v127, 0
    v_mov_b32 v128, 0
    v_mov_b32 v129, 0
    v_mov_b32 v130, 0
    v_mov_b32 v131, 0
    v_mov_b32 v132, 0
    v_mov_b32 v133, 0
    v_mov_b32 v134, 0
    v_mov_b32 v135, 0
    s_barrier
    ds_read_b128 v[168:171], v16
    ds_read_b64_tr_b16 v[184:185], v20 offset:0
    ds_read_b64_tr_b16 v[186:187], v20 offset:1024
    ds_read_b64_tr_b16 v[32:33], v21 offset:0
    ds_read_b64_tr_b16 v[34:35], v21 offset:1024
    ds_read_b64_tr_b16 v[36:37], v22 offset:0
    ds_read_b64_tr_b16 v[38:39], v22 offset:1024
    ds_read_b64_tr_b16 v[40:41], v23 offset:0
    ds_read_b64_tr_b16 v[42:43], v23 offset:1024
    s_mov_b32 s34, 0
    s_mov_b32 s41, 0x8000
    s_cmp_ge_u32 s30, 10
    s_cbranch_scc1 K1_loopV
K1_loopQ:
    s_waitcnt lgkmcnt(6)
    v_mfma_f32_32x32x16_bf16 v[72:87], v[184:187], v[168:171], v[72:87]
    ds_read_b128 v[172:175], v17
    ds_read_b64_tr_b16 v[188:189], v20 offset:4096
    ds_read_b64_tr_b16 v[190:191], v20 offset:5120
    s_waitcnt lgkmcnt(7)
    v_mfma_f32_32x32x16_bf16 v[88:103], v[32:35], v[168:171], v[88:103]
    ds_read_b64_tr_b16 v[44:45], v21 offset:4096
    ds_read_b64_tr_b16 v[46:47], v21 offset:5120
    s_waitcnt lgkmcnt(7)
    v_mfma_f32_32x32x16_bf16 v[104:119], v[36:39], v[168:171], v[104:119]
    ds_read_b64_tr_b16 v[48:49], v22 offset:4096
    ds_read_b64_tr_b16 v[50:51], v22 offset:5120
    s_waitcnt lgkmcnt(7)
    v_mfma_f32_32x32x16_bf16 v[120:135], v[40:43], v[168:171], v[120:135]
    ds_read_b64_tr_b16 v[52:53], v23 offset:4096
    ds_read_b64_tr_b16 v[54:55], v23 offset:5120
    s_waitcnt lgkmcnt(6)
    v_mfma_f32_32x32x16_bf16 v[72:87], v[188:191], v[172:175], v[72:87]
    ds_read_b128 v[176:179], v18
    ds_read_b64_tr_b16 v[192:193], v20 offset:8192
    ds_read_b64_tr_b16 v[194:195], v20 offset:9216
    s_waitcnt lgkmcnt(7)
    v_mfma_f32_32x32x16_bf16 v[88:103], v[44:47], v[172:175], v[88:103]
    ds_read_b64_tr_b16 v[32:33], v21 offset:8192
    ds_read_b64_tr_b16 v[34:35], v21 offset:9216
    s_waitcnt lgkmcnt(7)
    v_mfma_f32_32x32x16_bf16 v[104:119], v[48:51], v[172:175], v[104:119]
    ds_read_b64_tr_b16 v[36:37], v22 offset:8192
    ds_read_b64_tr_b16 v[38:39], v22 offset:9216
    s_waitcnt lgkmcnt(7)
    v_mfma_f32_32x32x16_bf16 v[120:135], v[52:55], v[172:175], v[120:135]
    ds_read_b64_tr_b16 v[40:41], v23 offset:8192
    ds_read_b64_tr_b16 v[42:43], v23 offset:9216
    s_waitcnt lgkmcnt(6)
    v_mfma_f32_32x32x16_bf16 v[72:87], v[192:195], v[176:179], v[72:87]
    ds_read_b128 v[180:183], v19
    ds_read_b64_tr_b16 v[196:197], v20 offset:12288
    ds_read_b64_tr_b16 v[198:199], v20 offset:13312
    s_waitcnt lgkmcnt(7)
    v_mfma_f32_32x32x16_bf16 v[88:103], v[32:35], v[176:179], v[88:103]
    ds_read_b64_tr_b16 v[44:45], v21 offset:12288
    ds_read_b64_tr_b16 v[46:47], v21 offset:13312
    s_waitcnt lgkmcnt(7)
    v_mfma_f32_32x32x16_bf16 v[104:119], v[36:39], v[176:179], v[104:119]
    ds_read_b64_tr_b16 v[48:49], v22 offset:12288
    ds_read_b64_tr_b16 v[50:51], v22 offset:13312
    s_waitcnt lgkmcnt(7)
    v_mfma_f32_32x32x16_bf16 v[120:135], v[40:43], v[176:179], v[120:135]
    ds_read_b64_tr_b16 v[52:53], v23 offset:12288
    ds_read_b64_tr_b16 v[54:55], v23 offset:13312
    s_add_u32 s34, s34, 1
    s_and_b32 s37, s34, 3
    s_cselect_b32 s35, s41, 0xfffe8000
    v_add_u32 v16, s35, v16
    v_add_u32 v17, s35, v17
    v_add_u32 v18, s35, v18
    v_add_u32 v19, s35, v19
    v_add_u32 v20, s35, v20
    v_add_u32 v21, s35, v21
    v_add_u32 v22, s35, v22
    v_add_u32 v23, s35, v23
    v_dot2c_f32_bf16 v28, s36, v184
    v_dot2c_f32_bf16 v29, s36, v185
    v_dot2c_f32_bf16 v28, s36, v186
    v_dot2c_f32_bf16 v29, s36, v187
    v_dot2c_f32_bf16 v28, s36, v188
    v_dot2c_f32_bf16 v29, s36, v189
    v_dot2c_f32_bf16 v28, s36, v190
    v_dot2c_f32_bf16 v29, s36, v191
    v_dot2c_f32_bf16 v28, s36, v192
    v_dot2c_f32_bf16 v29, s36, v193
    v_dot2c_f32_bf16 v28, s36, v194
    v_dot2c_f32_bf16 v29, s36, v195
    s_waitcnt lgkmcnt(0)
    v_dot2c_f32_bf16 v28, s36, v196
    v_dot2c_f32_bf16 v29, s36, v197
    v_dot2c_f32_bf16 v28, s36, v198
    v_dot2c_f32_bf16 v29, s36, v199
    s_cmp_lt_u32 s34, 10
    s_barrier
    v_mfma_f32_32x32x16_bf16 v[72:87], v[196:199], v[180:183], v[72:87]
    ds_read_b128 v[168:171], v16
    ds_read_b64_tr_b16 v[184:185], v20 offset:0
    ds_read_b64_tr_b16 v[186:187], v20 offset:1024
    v_mfma_f32_32x32x16_bf16 v[88:103], v[44:47], v[180:183], v[88:103]
    ds_read_b64_tr_b16 v[32:33], v21 offset:0
    ds_read_b64_tr_b16 v[34:35], v21 offset:1024
    v_mfma_f32_32x32x16_bf16 v[104:119], v[48:51], v[180:183], v[104:119]
    ds_read_b64_tr_b16 v[36:37], v22 offset:0
    ds_read_b64_tr_b16 v[38:39], v22 offset:1024
    v_mfma_f32_32x32x16_bf16 v[120:135], v[52:55], v[180:183], v[120:135]
    ds_read_b64_tr_b16 v[40:41], v23 offset:0
    ds_read_b64_tr_b16 v[42:43], v23 offset:1024
    s_cbranch_scc1 K1_loopQ
    s_branch K1_epi
K1_loopV:
    s_waitcnt lgkmcnt(6)
    v_mfma_f32_32x32x16_bf16 v[72:87], v[168:171], v[184:187], v[72:87]
    ds_read_b128 v[172:175], v17
    ds_read_b64_tr_b16 v[188:189], v20 offset:4096
    ds_read_b64_tr_b16 v[190:191], v20 offset:5120
    s_waitcnt lgkmcnt(7)
    v_mfma_f32_32x32x16_bf16 v[88:103], v[168:171], v[32:35], v[88:103]
    ds_read_b64_tr_b16 v[44:45], v21 offset:4096
    ds_read_b64_tr_b16 v[46:47], v21 offset:5120
    s_waitcnt lgkmcnt(7)
    v_mfma_f32_32x32x16_bf16 v[104:119], v[168:171], v[36:39], v[104:119]
    ds_read_b64_tr_b16 v[48:49], v22 offset:4096
    ds_read_b64_tr_b16 v[50:51], v22 offset:5120
    s_waitcnt lgkmcnt(7)
    v_mfma_f32_32x32x16_bf16 v[120:135], v[168:171], v[40:43], v[120:135]
    ds_read_b64_tr_b16 v[52:53], v23 offset:4096
    ds_read_b64_tr_b16 v[54:55], v23 offset:5120
    s_waitcnt lgkmcnt(6)
    v_mfma_f32_32x32x16_bf16 v[72:87], v[172:175], v[188:191], v[72:87]
    ds_read_b128 v[176:179], v18
    ds_read_b64_tr_b16 v[192:193], v20 offset:8192
    ds_read_b64_tr_b16 v[194:195], v20 offset:9216
    s_waitcnt lgkmcnt(7)
    v_mfma_f32_32x32x16_bf16 v[88:103], v[172:175], v[44:47], v[88:103]
    ds_read_b64_tr_b16 v[32:33], v21 offset:8192
    ds_read_b64_tr_b16 v[34:35], v21 offset:9216
    s_waitcnt lgkmcnt(7)
    v_mfma_f32_32x32x16_bf16 v[104:119], v[172:175], v[48:51], v[104:119]
    ds_read_b64_tr_b16 v[36:37], v22 offset:8192
    ds_read_b64_tr_b16 v[38:39], v22 offset:9216
    s_waitcnt lgkmcnt(7)
    v_mfma_f32_32x32x16_bf16 v[120:135], v[172:175], v[52:55], v[120:135]
    ds_read_b64_tr_b16 v[40:41], v23 offset:8192
    ds_read_b64_tr_b16 v[42:43], v23 offset:9216
    s_waitcnt lgkmcnt(6)
    v_mfma_f32_32x32x16_bf16 v[72:87], v[176:179], v[192:195], v[72:87]
    ds_read_b128 v[180:183], v19
    ds_read_b64_tr_b16 v[196:197], v20 offset:12288
    ds_read_b64_tr_b16 v[198:199], v20 offset:13312
    s_waitcnt lgkmcnt(7)
    v_mfma_f32_32x32x16_bf16 v[88:103], v[176:179], v[32:35], v[88:103]
    ds_read_b64_tr_b16 v[44:45], v21 offset:12288
    ds_read_b64_tr_b16 v[46:47], v21 offset:13312
    s_waitcnt lgkmcnt(7)
    v_mfma_f32_32x32x16_bf16 v[104:119], v[176:179], v[36:39], v[104:119]
    ds_read_b64_tr_b16 v[48:49], v22 offset:12288
    ds_read_b64_tr_b16 v[50:51], v22 offset:13312
    s_waitcnt lgkmcnt(7)
    v_mfma_f32_32x32x16_bf16 v[120:135], v[176:179], v[40:43], v[120:135]
    ds_read_b64_tr_b16 v[52:53], v23 offset:12288
    ds_read_b64_tr_b16 v[54:55], v23 offset:13312
    s_add_u32 s34, s34, 1
    s_and_b32 s37, s34, 3
    s_cselect_b32 s35, s41, 0xfffe8000
    v_add_u32 v16, s35, v16
    v_add_u32 v17, s35, v17
    v_add_u32 v18, s35, v18
    v_add_u32 v19, s35, v19
    v_add_u32 v20, s35, v20
    v_add_u32 v21, s35, v21
    v_add_u32 v22, s35, v22
    v_add_u32 v23, s35, v23
    v_dot2c_f32_bf16 v28, s36, v184
    v_dot2c_f32_bf16 v29, s36, v185
    v_dot2c_f32_bf16 v28, s36, v186
    v_dot2c_f32_bf16 v29, s36, v187
    v_dot2c_f32_bf16 v28, s36, v188
    v_dot2c_f32_bf16 v29, s36, v189
    v_dot2c_f32_bf16 v28, s36, v190
    v_dot2c_f32_bf16 v29, s36, v191
    v_dot2c_f32_bf16 v28, s36, v192
    v_dot2c_f32_bf16 v29, s36, v193
    v_dot2c_f32_bf16 v28, s36, v194
    v_dot2c_f32_bf16 v29, s36, v195
    s_waitcnt lgkmcnt(0)
    v_dot2c_f32_bf16 v28, s36, v196
    v_dot2c_f32_bf16 v29, s36, v197
    v_dot2c_f32_bf16 v28, s36, v198
    v_dot2c_f32_bf16 v29, s36, v199
    s_cmp_lt_u32 s34, 10
    s_barrier
    v_mfma_f32_32x32x16_bf16 v[72:87], v[180:183], v[196:199], v[72:87]
    ds_read_b128 v[168:171], v16
    ds_read_b64_tr_b16 v[184:185], v20 offset:0
    ds_read_b64_tr_b16 v[186:187], v20 offset:1024
    v_mfma_f32_32x32x16_bf16 v[88:103], v[180:183], v[44:47], v[88:103]
    ds_read_b64_tr_b16 v[32:33], v21 offset:0
    ds_read_b64_tr_b16 v[34:35], v21 offset:1024
    v_mfma_f32_32x32x16_bf16 v[104:119], v[180:183], v[48:51], v[104:119]
    ds_read_b64_tr_b16 v[36:37], v22 offset:0
    ds_read_b64_tr_b16 v[38:39], v22 offset:1024
    v_mfma_f32_32x32x16_bf16 v[120:135], v[180:183], v[52:55], v[120:135]
    ds_read_b64_tr_b16 v[40:41], v23 offset:0
    ds_read_b64_tr_b16 v[42:43], v23 offset:1024
    s_cbranch_scc1 K1_loopV
K1_epi:
    v_add_f32 v28, v28, v29
    v_and_b32 v1, 31, v0
    v_mov_b32 v29, v28
    v_lshlrev_b32 v2, 2, v1
    v_add_u32 v2, 0x20000, v2
    v_permlane32_swap_b32 v28, v29
    s_lshl_b32 s10, s28, 7
    v_add_u32 v3, s10, v2
    v_add_f32 v28, v28, v29
    ds_write_b32 v3, v28
    s_lshl_b32 s11, s28, 8
    v_add_u32 v3, s11, v2
    v_lshrrev_b32 v4, 5, v0
    s_lshl_b32 s38, s29, 2
    s_add_u32 s38, s38, s28
    s_cmp_ge_u32 s30, 10
    s_cbranch_scc1 K1_epiV
    v_lshlrev_b32 v5, 4, v4
    v_add_u32 v5, 0x20000, v5
    s_waitcnt lgkmcnt(0)
    s_barrier
    ds_read_b32 v24, v3 offset:512
    ds_read_b32 v26, v3 offset:640
    s_add_u32 s10, s28, 0
    s_and_b32 s10, s10, 3
    s_lshl_b32 s11, s10, 7
    v_add_u32 v6, s11, v5
    s_lshl_b32 s46, s10, 17
    ds_read_b128 v[136:139], v6 offset:0
    ds_read_b128 v[140:143], v6 offset:32
    ds_read_b128 v[144:147], v6 offset:64
    ds_read_b128 v[148:151], v6 offset:96
    s_add_u32 s10, s28, 1
    s_and_b32 s10, s10, 3
    s_lshl_b32 s11, s10, 7
    v_add_u32 v6, s11, v5
    s_lshl_b32 s47, s10, 17
    ds_read_b128 v[152:155], v6 offset:0
    ds_read_b128 v[156:159], v6 offset:32
    ds_read_b128 v[160:163], v6 offset:64
    ds_read_b128 v[164:167], v6 offset:96
    s_add_u32 s10, s28, 2
    s_and_b32 s10, s10, 3
    s_lshl_b32 s11, s10, 7
    v_add_u32 v6, s11, v5
    s_lshl_b32 s48, s10, 17
    ds_read_b128 v[168:171], v6 offset:0
    ds_read_b128 v[172:175], v6 offset:32
    ds_read_b128 v[176:179], v6 offset:64
    ds_read_b128 v[180:183], v6 offset:96
    s_add_u32 s10, s28, 3
    s_and_b32 s10, s10, 3
    s_lshl_b32 s11, s10, 7
    v_add_u32 v6, s11, v5
    s_lshl_b32 s49, s10, 17
    ds_read_b128 v[184:187], v6 offset:0
    ds_read_b128 v[188:191], v6 offset:32
    ds_read_b128 v[192:195], v6 offset:64
    ds_read_b128 v[196:199], v6 offset:96
    s_cmp_lt_u32 s30, 5
    s_cselect_b32 s10, 0x3ea52b5c, 1.0
    s_waitcnt lgkmcnt(12)
    v_mul_f32 v26, s10, v26
    v_and_b32 v2, 4, v1
    v_and_b32 v3, 8, v1
    v_and_b32 v5, 19, v1
    v_lshl_or_b32 v2, v2, 1, v5
    v_lshrrev_b32 v3, 1, v3
    v_or_b32 v2, v2, v3
    s_cselect_b64 vcc, -1, 0
    s_lshl_b32 s39, s30, 19
    s_lshl_b32 s11, s38, 9
    v_cndmask_b32 v2, v2, v1, vcc
    v_lshlrev_b32 v2, 4, v2
    v_lshl_add_u32 v2, v4, 15, v2
    s_add_u32 s39, s39, s11
    s_add_u32 s40, s39, s46
    s_waitcnt lgkmcnt(12)
    v_pk_fma_f32 v[72:73], v[136:137], v[24:25], v[72:73] op_sel_hi:[1,0,1]
    v_pk_fma_f32 v[74:75], v[138:139], v[24:25], v[74:75] op_sel_hi:[1,0,1]
    v_pk_fma_f32 v[76:77], v[140:141], v[24:25], v[76:77] op_sel_hi:[1,0,1]
    v_pk_fma_f32 v[78:79], v[142:143], v[24:25], v[78:79] op_sel_hi:[1,0,1]
    v_pk_fma_f32 v[80:81], v[144:145], v[24:25], v[80:81] op_sel_hi:[1,0,1]
    v_pk_fma_f32 v[82:83], v[146:147], v[24:25], v[82:83] op_sel_hi:[1,0,1]
    v_pk_fma_f32 v[84:85], v[148:149], v[24:25], v[84:85] op_sel_hi:[1,0,1]
    v_pk_fma_f32 v[86:87], v[150:151], v[24:25], v[86:87] op_sel_hi:[1,0,1]
    v_pk_mul_f32 v[72:73], v[72:73], v[26:27] op_sel_hi:[1,0]
    v_pk_mul_f32 v[74:75], v[74:75], v[26:27] op_sel_hi:[1,0]
    v_pk_mul_f32 v[76:77], v[76:77], v[26:27] op_sel_hi:[1,0]
    v_pk_mul_f32 v[78:79], v[78:79], v[26:27] op_sel_hi:[1,0]
    v_pk_mul_f32 v[80:81], v[80:81], v[26:27] op_sel_hi:[1,0]
    v_pk_mul_f32 v[82:83], v[82:83], v[26:27] op_sel_hi:[1,0]
    v_pk_mul_f32 v[84:85], v[84:85], v[26:27] op_sel_hi:[1,0]
    v_pk_mul_f32 v[86:87], v[86:87], v[26:27] op_sel_hi:[1,0]
    v_cvt_pk_bf16_f32 v72, v72, v73
    v_cvt_pk_bf16_f32 v73, v74, v75
    v_cvt_pk_bf16_f32 v74, v76, v77
    v_cvt_pk_bf16_f32 v75, v78, v79
    v_cvt_pk_bf16_f32 v80, v80, v81
    v_cvt_pk_bf16_f32 v81, v82, v83
    v_cvt_pk_bf16_f32 v82, v84, v85
    v_cvt_pk_bf16_f32 v83, v86, v87
    v_permlane32_swap_b32 v72, v74
    v_permlane32_swap_b32 v73, v75
    v_permlane32_swap_b32 v80, v82
    v_permlane32_swap_b32 v81, v83
    buffer_store_dwordx4 v[72:75], v2, s[24:27], s40 offen
    s_add_u32 s40, s40, 65536
    buffer_store_dwordx4 v[80:83], v2, s[24:27], s40 offen
    s_add_u32 s40, s39, s47
    s_waitcnt lgkmcnt(8)
    v_pk_fma_f32 v[88:89], v[152:153], v[24:25], v[88:89] op_sel_hi:[1,0,1]
    v_pk_fma_f32 v[90:91], v[154:155], v[24:25], v[90:91] op_sel_hi:[1,0,1]
    v_pk_fma_f32 v[92:93], v[156:157], v[24:25], v[92:93] op_sel_hi:[1,0,1]
    v_pk_fma_f32 v[94:95], v[158:159], v[24:25], v[94:95] op_sel_hi:[1,0,1]
    v_pk_fma_f32 v[96:97], v[160:161], v[24:25], v[96:97] op_sel_hi:[1,0,1]
    v_pk_fma_f32 v[98:99], v[162:163], v[24:25], v[98:99] op_sel_hi:[1,0,1]
    v_pk_fma_f32 v[100:101], v[164:165], v[24:25], v[100:101] op_sel_hi:[1,0,1]
    v_pk_fma_f32 v[102:103], v[166:167], v[24:25], v[102:103] op_sel_hi:[1,0,1]
    v_pk_mul_f32 v[88:89], v[88:89], v[26:27] op_sel_hi:[1,0]
    v_pk_mul_f32 v[90:91], v[90:91], v[26:27] op_sel_hi:[1,0]
    v_pk_mul_f32 v[92:93], v[92:93], v[26:27] op_sel_hi:[1,0]
    v_pk_mul_f32 v[94:95], v[94:95], v[26:27] op_sel_hi:[1,0]
    v_pk_mul_f32 v[96:97], v[96:97], v[26:27] op_sel_hi:[1,0]
    v_pk_mul_f32 v[98:99], v[98:99], v[26:27] op_sel_hi:[1,0]
    v_pk_mul_f32 v[100:101], v[100:101], v[26:27] op_sel_hi:[1,0]
    v_pk_mul_f32 v[102:103], v[102:103], v[26:27] op_sel_hi:[1,0]
    v_cvt_pk_bf16_f32 v88, v88, v89
    v_cvt_pk_bf16_f32 v89, v90, v91
    v_cvt_pk_bf16_f32 v90, v92, v93
    v_cvt_pk_bf16_f32 v91, v94, v95
    v_cvt_pk_bf16_f32 v96, v96, v97
    v_cvt_pk_bf16_f32 v97, v98, v99
    v_cvt_pk_bf16_f32 v98, v100, v101
    v_cvt_pk_bf16_f32 v99, v102, v103
    v_permlane32_swap_b32 v88, v90
    v_permlane32_swap_b32 v89, v91
    v_permlane32_swap_b32 v96, v98
    v_permlane32_swap_b32 v97, v99
    buffer_store_dwordx4 v[88:91], v2, s[24:27], s40 offen
    s_add_u32 s40, s40, 65536
    buffer_store_dwordx4 v[96:99], v2, s[24:27], s40 offen
    s_add_u32 s40, s39, s48
    s_waitcnt lgkmcnt(4)
    v_pk_fma_f32 v[104:105], v[168:169], v[24:25], v[104:105] op_sel_hi:[1,0,1]
    v_pk_fma_f32 v[106:107], v[170:171], v[24:25], v[106:107] op_sel_hi:[1,0,1]
    v_pk_fma_f32 v[108:109], v[172:173], v[24:25], v[108:109] op_sel_hi:[1,0,1]
    v_pk_fma_f32 v[110:111], v[174:175], v[24:25], v[110:111] op_sel_hi:[1,0,1]
    v_pk_fma_f32 v[112:113], v[176:177], v[24:25], v[112:113] op_sel_hi:[1,0,1]
    v_pk_fma_f32 v[114:115], v[178:179], v[24:25], v[114:115] op_sel_hi:[1,0,1]
    v_pk_fma_f32 v[116:117], v[180:181], v[24:25], v[116:117] op_sel_hi:[1,0,1]
    v_pk_fma_f32 v[118:119], v[182:183], v[24:25], v[118:119] op_sel_hi:[1,0,1]
    v_pk_mul_f32 v[104:105], v[104:105], v[26:27] op_sel_hi:[1,0]
    v_pk_mul_f32 v[106:107], v[106:107], v[26:27] op_sel_hi:[1,0]
    v_pk_mul_f32 v[108:109], v[108:109], v[26:27] op_sel_hi:[1,0]
    v_pk_mul_f32 v[110:111], v[110:111], v[26:27] op_sel_hi:[1,0]
    v_pk_mul_f32 v[112:113], v[112:113], v[26:27] op_sel_hi:[1,0]
    v_pk_mul_f32 v[114:115], v[114:115], v[26:27] op_sel_hi:[1,0]
    v_pk_mul_f32 v[116:117], v[116:117], v[26:27] op_sel_hi:[1,0]
    v_pk_mul_f32 v[118:119], v[118:119], v[26:27] op_sel_hi:[1,0]
    v_cvt_pk_bf16_f32 v104, v104, v105
    v_cvt_pk_bf16_f32 v105, v106, v107
    v_cvt_pk_bf16_f32 v106, v108, v109
    v_cvt_pk_bf16_f32 v107, v110, v111
    v_cvt_pk_bf16_f32 v112, v112, v113
    v_cvt_pk_bf16_f32 v113, v114, v115
    v_cvt_pk_bf16_f32 v114, v116, v117
    v_cvt_pk_bf16_f32 v115, v118, v119
    v_permlane32_swap_b32 v104, v106
    v_permlane32_swap_b32 v105, v107
    v_permlane32_swap_b32 v112, v114
    v_permlane32_swap_b32 v113, v115
    buffer_store_dwordx4 v[104:107], v2, s[24:27], s40 offen
    s_add_u32 s40, s40, 65536
    buffer_store_dwordx4 v[112:115], v2, s[24:27], s40 offen
    s_add_u32 s40, s39, s49
    s_waitcnt lgkmcnt(0)
    v_pk_fma_f32 v[120:121], v[184:185], v[24:25], v[120:121] op_sel_hi:[1,0,1]
    v_pk_fma_f32 v[122:123], v[186:187], v[24:25], v[122:123] op_sel_hi:[1,0,1]
    v_pk_fma_f32 v[124:125], v[188:189], v[24:25], v[124:125] op_sel_hi:[1,0,1]
    v_pk_fma_f32 v[126:127], v[190:191], v[24:25], v[126:127] op_sel_hi:[1,0,1]
    v_pk_fma_f32 v[128:129], v[192:193], v[24:25], v[128:129] op_sel_hi:[1,0,1]
    v_pk_fma_f32 v[130:131], v[194:195], v[24:25], v[130:131] op_sel_hi:[1,0,1]
    v_pk_fma_f32 v[132:133], v[196:197], v[24:25], v[132:133] op_sel_hi:[1,0,1]
    v_pk_fma_f32 v[134:135], v[198:199], v[24:25], v[134:135] op_sel_hi:[1,0,1]
    v_pk_mul_f32 v[120:121], v[120:121], v[26:27] op_sel_hi:[1,0]
    v_pk_mul_f32 v[122:123], v[122:123], v[26:27] op_sel_hi:[1,0]
    v_pk_mul_f32 v[124:125], v[124:125], v[26:27] op_sel_hi:[1,0]
    v_pk_mul_f32 v[126:127], v[126:127], v[26:27] op_sel_hi:[1,0]
    v_pk_mul_f32 v[128:129], v[128:129], v[26:27] op_sel_hi:[1,0]
    v_pk_mul_f32 v[130:131], v[130:131], v[26:27] op_sel_hi:[1,0]
    v_pk_mul_f32 v[132:133], v[132:133], v[26:27] op_sel_hi:[1,0]
    v_pk_mul_f32 v[134:135], v[134:135], v[26:27] op_sel_hi:[1,0]
    v_cvt_pk_bf16_f32 v120, v120, v121
    v_cvt_pk_bf16_f32 v121, v122, v123
    v_cvt_pk_bf16_f32 v122, v124, v125
    v_cvt_pk_bf16_f32 v123, v126, v127
    v_cvt_pk_bf16_f32 v128, v128, v129
    v_cvt_pk_bf16_f32 v129, v130, v131
    v_cvt_pk_bf16_f32 v130, v132, v133
    v_cvt_pk_bf16_f32 v131, v134, v135
    v_permlane32_swap_b32 v120, v122
    v_permlane32_swap_b32 v121, v123
    v_permlane32_swap_b32 v128, v130
    v_permlane32_swap_b32 v129, v131
    buffer_store_dwordx4 v[120:123], v2, s[24:27], s40 offen
    s_add_u32 s40, s40, 65536
    buffer_store_dwordx4 v[128:131], v2, s[24:27], s40 offen
    s_branch K1_fin
K1_epiV:
    v_lshlrev_b32 v5, 4, v4
    v_add_u32 v5, s11, v5
    v_add_u32 v5, 0x20000, v5
    v_mov_b32 v6, v2
    v_mul_u32_u24 v2, 10368, v4
    v_lshl_add_u32 v2, v1, 4, v2
    s_waitcnt lgkmcnt(0)
    s_barrier
    ds_read_b128 v[136:139], v5 offset:512
    ds_read_b128 v[140:143], v5 offset:544
    ds_read_b128 v[144:147], v5 offset:576
    ds_read_b128 v[148:151], v5 offset:608
    s_add_u32 s10, s28, 0
    s_and_b32 s10, s10, 3
    s_lshl_b32 s11, s10, 7
    v_add_u32 v7, s11, v6
    ds_read_b32 v168, v7
    s_lshl_b32 s46, s10, 9
    s_add_u32 s10, s28, 1
    s_and_b32 s10, s10, 3
    s_lshl_b32 s11, s10, 7
    v_add_u32 v7, s11, v6
    ds_read_b32 v170, v7
    s_lshl_b32 s47, s10, 9
    s_add_u32 s10, s28, 2
    s_and_b32 s10, s10, 3
    s_lshl_b32 s11, s10, 7
    v_add_u32 v7, s11, v6
    ds_read_b32 v172, v7
    s_lshl_b32 s48, s10, 9
    s_add_u32 s10, s28, 3
    s_and_b32 s10, s10, 3
    s_lshl_b32 s11, s10, 7
    v_add_u32 v7, s11, v6
    ds_read_b32 v174, v7
    s_lshl_b32 s49, s10, 9
    ds_read_b128 v[152:155], v5 offset:640
    ds_read_b128 v[156:159], v5 offset:672
    ds_read_b128 v[160:163], v5 offset:704
    ds_read_b128 v[164:167], v5 offset:736
    s_mul_i32 s39, s38, 41472
    s_sub_u32 s10, s30, 10
    s_lshl_b32 s10, s10, 11
    s_add_u32 s39, s39, s10
    s_add_u32 s39, s39, 5242880
    s_waitcnt lgkmcnt(4)
    s_add_u32 s40, s39, s46
    v_pk_fma_f32 v[72:73], v[136:137], v[168:169], v[72:73] op_sel_hi:[1,0,1]
    v_pk_fma_f32 v[74:75], v[138:139], v[168:169], v[74:75] op_sel_hi:[1,0,1]
    v_pk_fma_f32 v[76:77], v[140:141], v[168:169], v[76:77] op_sel_hi:[1,0,1]
    v_pk_fma_f32 v[78:79], v[142:143], v[168:169], v[78:79] op_sel_hi:[1,0,1]
    v_pk_fma_f32 v[80:81], v[144:145], v[168:169], v[80:81] op_sel_hi:[1,0,1]
    v_pk_fma_f32 v[82:83], v[146:147], v[168:169], v[82:83] op_sel_hi:[1,0,1]
    v_pk_fma_f32 v[84:85], v[148:149], v[168:169], v[84:85] op_sel_hi:[1,0,1]
    v_pk_fma_f32 v[86:87], v[150:151], v[168:169], v[86:87] op_sel_hi:[1,0,1]
    s_waitcnt lgkmcnt(0)
    v_pk_mul_f32 v[72:73], v[72:73], v[152:153]
    v_pk_mul_f32 v[74:75], v[74:75], v[154:155]
    v_pk_mul_f32 v[76:77], v[76:77], v[156:157]
    v_pk_mul_f32 v[78:79], v[78:79], v[158:159]
    v_pk_mul_f32 v[80:81], v[80:81], v[160:161]
    v_pk_mul_f32 v[82:83], v[82:83], v[162:163]
    v_pk_mul_f32 v[84:85], v[84:85], v[164:165]
    v_pk_mul_f32 v[86:87], v[86:87], v[166:167]
    v_cvt_pk_bf16_f32 v72, v72, v73
    v_cvt_pk_bf16_f32 v73, v74, v75
    v_cvt_pk_bf16_f32 v74, v76, v77
    v_cvt_pk_bf16_f32 v75, v78, v79
    v_cvt_pk_bf16_f32 v80, v80, v81
    v_cvt_pk_bf16_f32 v81, v82, v83
    v_cvt_pk_bf16_f32 v82, v84, v85
    v_cvt_pk_bf16_f32 v83, v86, v87
    v_permlane32_swap_b32 v72, v74
    v_permlane32_swap_b32 v73, v75
    v_permlane32_swap_b32 v80, v82
    v_permlane32_swap_b32 v81, v83
    buffer_store_dwordx4 v[72:75], v2, s[24:27], s40 offen
    s_add_u32 s40, s40, 20736
    buffer_store_dwordx4 v[80:83], v2, s[24:27], s40 offen
    s_add_u32 s40, s39, s47
    v_pk_fma_f32 v[88:89], v[136:137], v[170:171], v[88:89] op_sel_hi:[1,0,1]
    v_pk_fma_f32 v[90:91], v[138:139], v[170:171], v[90:91] op_sel_hi:[1,0,1]
    v_pk_fma_f32 v[92:93], v[140:141], v[170:171], v[92:93] op_sel_hi:[1,0,1]
    v_pk_fma_f32 v[94:95], v[142:143], v[170:171], v[94:95] op_sel_hi:[1,0,1]
    v_pk_fma_f32 v[96:97], v[144:145], v[170:171], v[96:97] op_sel_hi:[1,0,1]
    v_pk_fma_f32 v[98:99], v[146:147], v[170:171], v[98:99] op_sel_hi:[1,0,1]
    v_pk_fma_f32 v[100:101], v[148:149], v[170:171], v[100:101] op_sel_hi:[1,0,1]
    v_pk_fma_f32 v[102:103], v[150:151], v[170:171], v[102:103] op_sel_hi:[1,0,1]
    v_pk_mul_f32 v[88:89], v[88:89], v[152:153]
    v_pk_mul_f32 v[90:91], v[90:91], v[154:155]
    v_pk_mul_f32 v[92:93], v[92:93], v[156:157]
    v_pk_mul_f32 v[94:95], v[94:95], v[158:159]
    v_pk_mul_f32 v[96:97], v[96:97], v[160:161]
    v_pk_mul_f32 v[98:99], v[98:99], v[162:163]
    v_pk_mul_f32 v[100:101], v[100:101], v[164:165]
    v_pk_mul_f32 v[102:103], v[102:103], v[166:167]
    v_cvt_pk_bf16_f32 v88, v88, v89
    v_cvt_pk_bf16_f32 v89, v90, v91
    v_cvt_pk_bf16_f32 v90, v92, v93
    v_cvt_pk_bf16_f32 v91, v94, v95
    v_cvt_pk_bf16_f32 v96, v96, v97
    v_cvt_pk_bf16_f32 v97, v98, v99
    v_cvt_pk_bf16_f32 v98, v100, v101
    v_cvt_pk_bf16_f32 v99, v102, v103
    v_permlane32_swap_b32 v88, v90
    v_permlane32_swap_b32 v89, v91
    v_permlane32_swap_b32 v96, v98
    v_permlane32_swap_b32 v97, v99
    buffer_store_dwordx4 v[88:91], v2, s[24:27], s40 offen
    s_add_u32 s40, s40, 20736
    buffer_store_dwordx4 v[96:99], v2, s[24:27], s40 offen
    s_add_u32 s40, s39, s48
    v_pk_fma_f32 v[104:105], v[136:137], v[172:173], v[104:105] op_sel_hi:[1,0,1]
    v_pk_fma_f32 v[106:107], v[138:139], v[172:173], v[106:107] op_sel_hi:[1,0,1]
    v_pk_fma_f32 v[108:109], v[140:141], v[172:173], v[108:109] op_sel_hi:[1,0,1]
    v_pk_fma_f32 v[110:111], v[142:143], v[172:173], v[110:111] op_sel_hi:[1,0,1]
    v_pk_fma_f32 v[112:113], v[144:145], v[172:173], v[112:113] op_sel_hi:[1,0,1]
    v_pk_fma_f32 v[114:115], v[146:147], v[172:173], v[114:115] op_sel_hi:[1,0,1]
    v_pk_fma_f32 v[116:117], v[148:149], v[172:173], v[116:117] op_sel_hi:[1,0,1]
    v_pk_fma_f32 v[118:119], v[150:151], v[172:173], v[118:119] op_sel_hi:[1,0,1]
    v_pk_mul_f32 v[104:105], v[104:105], v[152:153]
    v_pk_mul_f32 v[106:107], v[106:107], v[154:155]
    v_pk_mul_f32 v[108:109], v[108:109], v[156:157]
    v_pk_mul_f32 v[110:111], v[110:111], v[158:159]
    v_pk_mul_f32 v[112:113], v[112:113], v[160:161]
    v_pk_mul_f32 v[114:115], v[114:115], v[162:163]
    v_pk_mul_f32 v[116:117], v[116:117], v[164:165]
    v_pk_mul_f32 v[118:119], v[118:119], v[166:167]
    v_cvt_pk_bf16_f32 v104, v104, v105
    v_cvt_pk_bf16_f32 v105, v106, v107
    v_cvt_pk_bf16_f32 v106, v108, v109
    v_cvt_pk_bf16_f32 v107, v110, v111
    v_cvt_pk_bf16_f32 v112, v112, v113
    v_cvt_pk_bf16_f32 v113, v114, v115
    v_cvt_pk_bf16_f32 v114, v116, v117
    v_cvt_pk_bf16_f32 v115, v118, v119
    v_permlane32_swap_b32 v104, v106
    v_permlane32_swap_b32 v105, v107
    v_permlane32_swap_b32 v112, v114
    v_permlane32_swap_b32 v113, v115
    buffer_store_dwordx4 v[104:107], v2, s[24:27], s40 offen
    s_add_u32 s40, s40, 20736
    buffer_store_dwordx4 v[112:115], v2, s[24:27], s40 offen
    s_add_u32 s40, s39, s49
    v_pk_fma_f32 v[120:121], v[136:137], v[174:175], v[120:121] op_sel_hi:[1,0,1]
    v_pk_fma_f32 v[122:123], v[138:139], v[174:175], v[122:123] op_sel_hi:[1,0,1]
    v_pk_fma_f32 v[124:125], v[140:141], v[174:175], v[124:125] op_sel_hi:[1,0,1]
    v_pk_fma_f32 v[126:127], v[142:143], v[174:175], v[126:127] op_sel_hi:[1,0,1]
    v_pk_fma_f32 v[128:129], v[144:145], v[174:175], v[128:129] op_sel_hi:[1,0,1]
    v_pk_fma_f32 v[130:131], v[146:147], v[174:175], v[130:131] op_sel_hi:[1,0,1]
    v_pk_fma_f32 v[132:133], v[148:149], v[174:175], v[132:133] op_sel_hi:[1,0,1]
    v_pk_fma_f32 v[134:135], v[150:151], v[174:175], v[134:135] op_sel_hi:[1,0,1]
    v_pk_mul_f32 v[120:121], v[120:121], v[152:153]
    v_pk_mul_f32 v[122:123], v[122:123], v[154:155]
    v_pk_mul_f32 v[124:125], v[124:125], v[156:157]
    v_pk_mul_f32 v[126:127], v[126:127], v[158:159]
    v_pk_mul_f32 v[128:129], v[128:129], v[160:161]
    v_pk_mul_f32 v[130:131], v[130:131], v[162:163]
    v_pk_mul_f32 v[132:133], v[132:133], v[164:165]
    v_pk_mul_f32 v[134:135], v[134:135], v[166:167]
    v_cvt_pk_bf16_f32 v120, v120, v121
    v_cvt_pk_bf16_f32 v121, v122, v123
    v_cvt_pk_bf16_f32 v122, v124, v125
    v_cvt_pk_bf16_f32 v123, v126, v127
    v_cvt_pk_bf16_f32 v128, v128, v129
    v_cvt_pk_bf16_f32 v129, v130, v131
    v_cvt_pk_bf16_f32 v130, v132, v133
    v_cvt_pk_bf16_f32 v131, v134, v135
    v_permlane32_swap_b32 v120, v122
    v_permlane32_swap_b32 v121, v123
    v_permlane32_swap_b32 v128, v130
    v_permlane32_swap_b32 v129, v131
    buffer_store_dwordx4 v[120:123], v2, s[24:27], s40 offen
    s_add_u32 s40, s40, 20736
    buffer_store_dwordx4 v[128:131], v2, s[24:27], s40 offen
K1_fin:
    s_endpgm
K1_spare:
    s_load_dwordx2 s[4:5], s[0:1], 64
    v_lshrrev_b32 v1, 3, v0
    v_and_b32 v2, 7, v0
    v_mul_u32_u24 v3, 1280, v1
    v_lshl_add_u32 v3, v2, 4, v3
    s_mul_i32 s10, s45, 20480
    s_add_u32 s10, s10, s42
    s_add_u32 s11, s10, 10240
    buffer_load_dwordx4 v[32:35], v3, s[16:19], s10 offen offset:0
    buffer_load_dwordx4 v[36:39], v3, s[16:19], s11 offen offset:0
    buffer_load_dwordx4 v[40:43], v3, s[16:19], s10 offen offset:128
    buffer_load_dwordx4 v[44:47], v3, s[16:19], s11 offen offset:128
    buffer_load_dwordx4 v[48:51], v3, s[16:19], s10 offen offset:256
    buffer_load_dwordx4 v[52:55], v3, s[16:19], s11 offen offset:256
    buffer_load_dwordx4 v[56:59], v3, s[16:19], s10 offen offset:384
    buffer_load_dwordx4 v[60:63], v3, s[16:19], s11 offen offset:384
    buffer_load_dwordx4 v[64:67], v3, s[16:19], s10 offen offset:512
    buffer_load_dwordx4 v[68:71], v3, s[16:19], s11 offen offset:512
    buffer_load_dwordx4 v[72:75], v3, s[16:19], s10 offen offset:640
    buffer_load_dwordx4 v[76:79], v3, s[16:19], s11 offen offset:640
    buffer_load_dwordx4 v[80:83], v3, s[16:19], s10 offen offset:768
    buffer_load_dwordx4 v[84:87], v3, s[16:19], s11 offen offset:768
    buffer_load_dwordx4 v[88:91], v3, s[16:19], s10 offen offset:896
    buffer_load_dwordx4 v[92:95], v3, s[16:19], s11 offen offset:896
    buffer_load_dwordx4 v[96:99], v3, s[16:19], s10 offen offset:1024
    buffer_load_dwordx4 v[100:103], v3, s[16:19], s11 offen offset:1024
    buffer_load_dwordx4 v[104:107], v3, s[16:19], s10 offen offset:1152
    buffer_load_dwordx4 v[108:111], v3, s[16:19], s11 offen offset:1152
    v_mov_b32 v8, 0
    v_mov_b32 v9, 0
    v_mov_b32 v10, 0
    v_mov_b32 v11, 0
    s_waitcnt vmcnt(19)
    v_dot2c_f32_bf16 v8, s36, v32
    v_dot2c_f32_bf16 v10, v32, v32
    v_dot2c_f32_bf16 v8, s36, v33
    v_dot2c_f32_bf16 v10, v33, v33
    v_dot2c_f32_bf16 v8, s36, v34
    v_dot2c_f32_bf16 v10, v34, v34
    v_dot2c_f32_bf16 v8, s36, v35
    v_dot2c_f32_bf16 v10, v35, v35
    s_waitcnt vmcnt(18)
    v_dot2c_f32_bf16 v9, s36, v36
    v_dot2c_f32_bf16 v11, v36, v36
    v_dot2c_f32_bf16 v9, s36, v37
    v_dot2c_f32_bf16 v11, v37, v37
    v_dot2c_f32_bf16 v9, s36, v38
    v_dot2c_f32_bf16 v11, v38, v38
    v_dot2c_f32_bf16 v9, s36, v39
    v_dot2c_f32_bf16 v11, v39, v39
    s_waitcnt vmcnt(17)
    v_dot2c_f32_bf16 v8, s36, v40
    v_dot2c_f32_bf16 v10, v40, v40
    v_dot2c_f32_bf16 v8, s36, v41
    v_dot2c_f32_bf16 v10, v41, v41
    v_dot2c_f32_bf16 v8, s36, v42
    v_dot2c_f32_bf16 v10, v42, v42
    v_dot2c_f32_bf16 v8, s36, v43
    v_dot2c_f32_bf16 v10, v43, v43
    s_waitcnt vmcnt(16)
    v_dot2c_f32_bf16 v9, s36, v44
    v_dot2c_f32_bf16 v11, v44, v44
    v_dot2c_f32_bf16 v9, s36, v45
    v_dot2c_f32_bf16 v11, v45, v45
    v_dot2c_f32_bf16 v9, s36, v46
    v_dot2c_f32_bf16 v11, v46, v46
    v_dot2c_f32_bf16 v9, s36, v47
    v_dot2c_f32_bf16 v11, v47, v47
    s_waitcnt vmcnt(15)
    v_dot2c_f32_bf16 v8, s36, v48
    v_dot2c_f32_bf16 v10, v48, v48
    v_dot2c_f32_bf16 v8, s36, v49
    v_dot2c_f32_bf16 v10, v49, v49
    v_dot2c_f32_bf16 v8, s36, v50
    v_dot2c_f32_bf16 v10, v50, v50
    v_dot2c_f32_bf16 v8, s36, v51
    v_dot2c_f32_bf16 v10, v51, v51
    s_waitcnt vmcnt(14)
    v_dot2c_f32_bf16 v9, s36, v52
    v_dot2c_f32_bf16 v11, v52, v52
    v_dot2c_f32_bf16 v9, s36, v53
    v_dot2c_f32_bf16 v11, v53, v53
    v_dot2c_f32_bf16 v9, s36, v54
    v_dot2c_f32_bf16 v11, v54, v54
    v_dot2c_f32_bf16 v9, s36, v55
    v_dot2c_f32_bf16 v11, v55, v55
    s_waitcnt vmcnt(13)
    v_dot2c_f32_bf16 v8, s36, v56
    v_dot2c_f32_bf16 v10, v56, v56
    v_dot2c_f32_bf16 v8, s36, v57
    v_dot2c_f32_bf16 v10, v57, v57
    v_dot2c_f32_bf16 v8, s36, v58
    v_dot2c_f32_bf16 v10, v58, v58
    v_dot2c_f32_bf16 v8, s36, v59
    v_dot2c_f32_bf16 v10, v59, v59
    s_waitcnt vmcnt(12)
    v_dot2c_f32_bf16 v9, s36, v60
    v_dot2c_f32_bf16 v11, v60, v60
    v_dot2c_f32_bf16 v9, s36, v61
    v_dot2c_f32_bf16 v11, v61, v61
    v_dot2c_f32_bf16 v9, s36, v62
    v_dot2c_f32_bf16 v11, v62, v62
    v_dot2c_f32_bf16 v9, s36, v63
    v_dot2c_f32_bf16 v11, v63, v63
    s_waitcnt vmcnt(11)
    v_dot2c_f32_bf16 v8, s36, v64
    v_dot2c_f32_bf16 v10, v64, v64
    v_dot2c_f32_bf16 v8, s36, v65
    v_dot2c_f32_bf16 v10, v65, v65
    v_dot2c_f32_bf16 v8, s36, v66
    v_dot2c_f32_bf16 v10, v66, v66
    v_dot2c_f32_bf16 v8, s36, v67
    v_dot2c_f32_bf16 v10, v67, v67
    s_waitcnt vmcnt(10)
    v_dot2c_f32_bf16 v9, s36, v68
    v_dot2c_f32_bf16 v11, v68, v68
    v_dot2c_f32_bf16 v9, s36, v69
    v_dot2c_f32_bf16 v11, v69, v69
    v_dot2c_f32_bf16 v9, s36, v70
    v_dot2c_f32_bf16 v11, v70, v70
    v_dot2c_f32_bf16 v9, s36, v71
    v_dot2c_f32_bf16 v11, v71, v71
    s_waitcnt vmcnt(9)
    v_dot2c_f32_bf16 v8, s36, v72
    v_dot2c_f32_bf16 v10, v72, v72
    v_dot2c_f32_bf16 v8, s36, v73
    v_dot2c_f32_bf16 v10, v73, v73
    v_dot2c_f32_bf16 v8, s36, v74
    v_dot2c_f32_bf16 v10, v74, v74
    v_dot2c_f32_bf16 v8, s36, v75
    v_dot2c_f32_bf16 v10, v75, v75
    s_waitcnt vmcnt(8)
    v_dot2c_f32_bf16 v9, s36, v76
    v_dot2c_f32_bf16 v11, v76, v76
    v_dot2c_f32_bf16 v9, s36, v77
    v_dot2c_f32_bf16 v11, v77, v77
    v_dot2c_f32_bf16 v9, s36, v78
    v_dot2c_f32_bf16 v11, v78, v78
    v_dot2c_f32_bf16 v9, s36, v79
    v_dot2c_f32_bf16 v11, v79, v79
    s_waitcnt vmcnt(7)
    v_dot2c_f32_bf16 v8, s36, v80
    v_dot2c_f32_bf16 v10, v80, v80
    v_dot2c_f32_bf16 v8, s36, v81
    v_dot2c_f32_bf16 v10, v81, v81
    v_dot2c_f32_bf16 v8, s36, v82
    v_dot2c_f32_bf16 v10, v82, v82
    v_dot2c_f32_bf16 v8, s36, v83
    v_dot2c_f32_bf16 v10, v83, v83
    s_waitcnt vmcnt(6)
    v_dot2c_f32_bf16 v9, s36, v84
    v_dot2c_f32_bf16 v11, v84, v84
    v_dot2c_f32_bf16 v9, s36, v85
    v_dot2c_f32_bf16 v11, v85, v85
    v_dot2c_f32_bf16 v9, s36, v86
    v_dot2c_f32_bf16 v11, v86, v86
    v_dot2c_f32_bf16 v9, s36, v87
    v_dot2c_f32_bf16 v11, v87, v87
    s_waitcnt vmcnt(5)
    v_dot2c_f32_bf16 v8, s36, v88
    v_dot2c_f32_bf16 v10, v88, v88
    v_dot2c_f32_bf16 v8, s36, v89
    v_dot2c_f32_bf16 v10, v89, v89
    v_dot2c_f32_bf16 v8, s36, v90
    v_dot2c_f32_bf16 v10, v90, v90
    v_dot2c_f32_bf16 v8, s36, v91
    v_dot2c_f32_bf16 v10, v91, v91
    s_waitcnt vmcnt(4)
    v_dot2c_f32_bf16 v9, s36, v92
    v_dot2c_f32_bf16 v11, v92, v92
    v_dot2c_f32_bf16 v9, s36, v93
    v_dot2c_f32_bf16 v11, v93, v93
    v_dot2c_f32_bf16 v9, s36, v94
    v_dot2c_f32_bf16 v11, v94, v94
    v_dot2c_f32_bf16 v9, s36, v95
    v_dot2c_f32_bf16 v11, v95, v95
    s_waitcnt vmcnt(3)
    v_dot2c_f32_bf16 v8, s36, v96
    v_dot2c_f32_bf16 v10, v96, v96
    v_dot2c_f32_bf16 v8, s36, v97
    v_dot2c_f32_bf16 v10, v97, v97
    v_dot2c_f32_bf16 v8, s36, v98
    v_dot2c_f32_bf16 v10, v98, v98
    v_dot2c_f32_bf16 v8, s36, v99
    v_dot2c_f32_bf16 v10, v99, v99
    s_waitcnt vmcnt(2)
    v_dot2c_f32_bf16 v9, s36, v100
    v_dot2c_f32_bf16 v11, v100, v100
    v_dot2c_f32_bf16 v9, s36, v101
    v_dot2c_f32_bf16 v11, v101, v101
    v_dot2c_f32_bf16 v9, s36, v102
    v_dot2c_f32_bf16 v11, v102, v102
    v_dot2c_f32_bf16 v9, s36, v103
    v_dot2c_f32_bf16 v11, v103, v103
    s_waitcnt vmcnt(1)
    v_dot2c_f32_bf16 v8, s36, v104
    v_dot2c_f32_bf16 v10, v104, v104
    v_dot2c_f32_bf16 v8, s36, v105
    v_dot2c_f32_bf16 v10, v105, v105
    v_dot2c_f32_bf16 v8, s36, v106
    v_dot2c_f32_bf16 v10, v106, v106
    v_dot2c_f32_bf16 v8, s36, v107
    v_dot2c_f32_bf16 v10, v107, v107
    s_waitcnt vmcnt(0)
    v_dot2c_f32_bf16 v9, s36, v108
    v_dot2c_f32_bf16 v11, v108, v108
    v_dot2c_f32_bf16 v9, s36, v109
    v_dot2c_f32_bf16 v11, v109, v109
    v_dot2c_f32_bf16 v9, s36, v110
    v_dot2c_f32_bf16 v11, v110, v110
    v_dot2c_f32_bf16 v9, s36, v111
    v_dot2c_f32_bf16 v11, v111, v111
    s_nop 3
    v_add_f32_dpp v8, v8, v8 quad_perm:[1,0,3,2] row_mask:0xf bank_mask:0xf
    v_add_f32_dpp v9, v9, v9 quad_perm:[1,0,3,2] row_mask:0xf bank_mask:0xf
    v_add_f32_dpp v10, v10, v10 quad_perm:[1,0,3,2] row_mask:0xf bank_mask:0xf
    v_add_f32_dpp v11, v11, v11 quad_perm:[1,0,3,2] row_mask:0xf bank_mask:0xf
    v_add_f32_dpp v8, v8, v8 quad_perm:[2,3,0,1] row_mask:0xf bank_mask:0xf
    v_add_f32_dpp v9, v9, v9 quad_perm:[2,3,0,1] row_mask:0xf bank_mask:0xf
    v_add_f32_dpp v10, v10, v10 quad_perm:[2,3,0,1] row_mask:0xf bank_mask:0xf
    v_add_f32_dpp v11, v11, v11 quad_perm:[2,3,0,1] row_mask:0xf bank_mask:0xf
    v_add_f32_dpp v8, v8, v8 row_half_mirror row_mask:0xf bank_mask:0xf
    v_add_f32_dpp v9, v9, v9 row_half_mirror row_mask:0xf bank_mask:0xf
    v_add_f32_dpp v10, v10, v10 row_half_mirror row_mask:0xf bank_mask:0xf
    v_add_f32_dpp v11, v11, v11 row_half_mirror row_mask:0xf bank_mask:0xf
    v_mul_f32 v8, 0xbacccccd, v8
    v_mul_f32 v10, 0x3acccccd, v10
    v_fma_f32 v10, -v8, v8, v10
    v_max_f32 v10, 0, v10
    v_add_f32 v10, 0x3727c5ac, v10
    v_rsq_f32 v10, v10
    v_mul_f32 v9, 0xbacccccd, v9
    v_mul_f32 v11, 0x3acccccd, v11
    v_fma_f32 v11, -v9, v9, v11
    v_max_f32 v11, 0, v11
    v_add_f32 v11, 0x3727c5ac, v11
    v_rsq_f32 v11, v11
    s_lshr_b32 s10, s45, 1
    s_lshl_b32 s10, s10, 8
    s_and_b32 s11, s45, 1
    s_lshl_b32 s11, s11, 6
    s_add_u32 s10, s10, s11
    v_lshl_add_u32 v4, v1, 2, s10
    ds_write_b32 v4, v8
    ds_write_b32 v4, v9 offset:32
    ds_write_b32 v4, v10 offset:128
    ds_write_b32 v4, v11 offset:160
    s_waitcnt lgkmcnt(0)
    s_barrier
    s_cmp_lg_u32 s45, 1
    s_cbranch_scc1 K1_sp0
    v_lshlrev_b32 v5, 4, v0
    ds_read_b128 v[12:15], v5
    s_lshl_b32 s10, s29, 10
    s_add_u32 s10, s10, 19922944
    s_mov_b32 s16, s4
    s_and_b32 s17, s5, 0xffff
    s_mov_b32 s18, 256
    s_mov_b32 s19, 0x00020000
    v_mov_b32 v6, 0
    v_mov_b32 v7, 1
    s_waitcnt lgkmcnt(0)
    buffer_store_dwordx4 v[12:15], v5, s[24:27], s10 offen sc1
    s_lshl_b32 s10, s29, 2
    s_waitcnt vmcnt(0)
    s_mov_b64 exec, 1
    buffer_store_dword v7, v6, s[16:19], s10 offen sc1
    s_mov_b64 exec, -1
    s_endpgm
K1_sp0:
    s_cmp_lg_u32 s45, 0
    s_cbranch_scc1 K1_end
    v_lshrrev_b32 v5, 2, v0
    s_lshl_b32 s10, s29, 4
    v_add_u32 v5, s10, v5
    v_mul_u32_u24 v5, 10368, v5
    v_and_b32 v6, 3, v0
    v_lshl_add_u32 v5, v6, 4, v5
    v_mov_b32 v16, s36
    v_mov_b32 v17, s36
    v_mov_b32 v18, s36
    v_mov_b32 v19, s36
    s_mov_b32 s10, 5253120
    buffer_store_dwordx4 v[16:19], v5, s[24:27], s10 offen
    v_lshlrev_b32 v5, 4, v0
    v_mov_b32 v20, 0
    v_mov_b32 v21, 0
    v_mov_b32 v22, 0
    v_mov_b32 v23, 0
    s_lshl_b32 s10, s29, 11
    s_add_u32 s10, s10, 27066368
    buffer_store_dwordx4 v[20:23], v5, s[24:27], s10 offen
    buffer_store_dwordx4 v[20:23], v5, s[24:27], s10 offen offset:1024
K1_end:
    s_endpgm
.globl mega_kernel
.p2align 8
.type mega_kernel,@function
mega_kernel:
    s_cmp_ge_u32 s2, 256
    s_cbranch_scc1 K2_end
    v_lshrrev_b32 v1, 6, v0
    v_and_b32 v0, 63, v0
    s_nop 0
    v_readfirstlane_b32 s28, v1
    s_load_dwordx2 s[8:9], s[0:1], 72
    s_load_dwordx2 s[4:5], s[0:1], 16
    s_load_dwordx4 s[12:15], s[0:1], 32
    s_load_dwordx2 s[6:7], s[0:1], 48
    s_load_dwordx2 s[50:51], s[0:1], 0
    s_load_dwordx2 s[52:53], s[0:1], 56
    s_and_b32 s3, s2, 7
    s_lshr_b32 s10, s2, 3
    s_lshr_b32 s29, s10, 3
    s_lshl_b32 s11, s3, 2
    s_add_u32 s29, s29, s11
    s_and_b32 s30, s10, 7
    s_lshl_b32 s54, s30, 1
    s_lshr_b32 s11, s3, 2
    s_add_u32 s54, s54, s11
    s_and_b32 s55, s29, 15
    s_lshl_b32 s56, s54, 1
    s_lshr_b32 s11, s55, 3
    s_add_u32 s56, s56, s11
    s_and_b32 s57, s55, 7
    v_and_b32 v1, 31, v0
    v_lshrrev_b32 v7, 5, v0
    s_and_b32 s42, s29, 1
    s_cselect_b32 s43, 8, 0x10000
    v_lshlrev_b32 v4, 4, v1
    v_add_u32 v3, s42, v7
    v_lshl_add_u32 v2, v3, 15, v4
    v_add_u32 v4, s43, v4
    v_lshl_add_u32 v4, v7, 30, v4
    s_mul_i32 s31, s29, 5
    s_lshr_b32 s31, s31, 1
    s_lshl_b32 s31, s31, 15
    s_lshl_b32 s10, s30, 3
    s_lshl_b32 s11, s28, 1
    s_add_u32 s38, s10, s11
    s_lshl_b32 s46, s38, 9
    s_add_u32 s46, s46, s31
    s_add_u32 s31, s31, 2621440
    s_cmp_ge_u32 s28, 4
    s_cbranch_scc1 K2_service
    s_waitcnt lgkmcnt(0)
    s_mov_b32 s24, s8
    s_and_b32 s25, s9, 0xffff
    s_mov_b32 s26, 34603008
    s_mov_b32 s27, 0x00020000
    buffer_load_dwordx4 v[8:11], v2, s[24:27], s46 offen
    buffer_load_dwordx2 v[12:13], v4, s[24:27], s46 offen
    buffer_load_dwordx4 v[160:163], v2, s[24:27], s31 offen offset:0
    buffer_load_dwordx2 v[164:165], v4, s[24:27], s31 offen offset:0
    buffer_load_dwordx4 v[16:19], v2, s[24:27], s46 offen offset:512
    buffer_load_dwordx2 v[20:21], v4, s[24:27], s46 offen offset:512
    v_lshlrev_b32 v23, 4, v1
    v_lshl_add_u32 v22, v3, 9, v23
    s_cmp_eq_u32 s42, 1
    s_cselect_b32 s43, 8, 0x400
    v_add_u32 v23, s43, v23
    v_and_b32 v26, 4, v1
    v_and_b32 v27, 8, v1
    v_and_b32 v31, 3, v1
    v_lshl_or_b32 v31, v26, 1, v31
    v_lshrrev_b32 v27, 1, v27
    v_or_b32 v31, v31, v27
    v_cmp_gt_u32 vcc, 16, v1
    v_min_u32 v27, 21, v1
    s_nop 0
    v_cndmask_b32 v31, v27, v31, vcc
    v_lshlrev_b32 v30, 4, v31
    v_mul_u32_u24 v26, 384, v7
    v_add_u32 v30, v30, v26
    v_mov_b32 v24, 0xff800000
    v_mov_b32 v25, 0xff800000
    v_add_u32 v30, 12288, v30
    v_mov_b32 v112, 0
    v_mov_b32 v113, 0
    v_mov_b32 v114, 0
    v_mov_b32 v115, 0
    v_mov_b32 v116, 0
    v_mov_b32 v117, 0
    v_mov_b32 v118, 0
    v_mov_b32 v119, 0
    v_mov_b32 v120, 0
    v_mov_b32 v121, 0
    v_mov_b32 v122, 0
    v_mov_b32 v123, 0
    v_mov_b32 v124, 0
    v_mov_b32 v125, 0
    v_mov_b32 v126, 0
    v_mov_b32 v127, 0
    v_mov_b32 v128, 0
    v_mov_b32 v129, 0
    v_mov_b32 v130, 0
    v_mov_b32 v131, 0
    v_mov_b32 v132, 0
    v_mov_b32 v133, 0
    v_mov_b32 v134, 0
    v_mov_b32 v135, 0
    v_mov_b32 v136, 0
    v_mov_b32 v137, 0
    v_mov_b32 v138, 0
    v_mov_b32 v139, 0
    v_mov_b32 v140, 0
    v_mov_b32 v141, 0
    v_mov_b32 v142, 0
    v_mov_b32 v143, 0
    v_mov_b32 v172, 0
    v_mov_b32 v173, 0
    v_mov_b32 v174, 0
    v_mov_b32 v175, 0
    v_mov_b32 v108, 0
    v_mov_b32 v109, 0
    v_mov_b32 v110, 0
    v_mov_b32 v111, 0
    s_mov_b32 s36, 0
    s_mov_b32 s37, 0
    s_mov_b32 s35, 0
    s_mov_b32 s41, 24576
    v_lshrrev_b32 v28, 4, v1
    v_lshlrev_b32 v28, 10, v28
    v_and_b32 v29, 15, v1
    v_lshl_add_u32 v28, v29, 4, v28
    v_lshlrev_b32 v29, 3, v29
    v_sub_u32 v29, v28, v29
    v_lshl_add_u32 v28, v7, 8, v28
    v_lshl_add_u32 v29, v7, 30, v29
    s_mul_i32 s58, s38, 40960
    s_add_u32 s58, s58, 8388608
    s_lshr_b32 s10, s29, 3
    s_lshl_b32 s10, s10, 12
    s_and_b32 s11, s29, 7
    s_lshl_b32 s11, s11, 7
    s_add_u32 s10, s10, s11
    s_add_u32 s59, s58, s10
    s_lshr_b32 s10, s29, 1
    s_lshl_b32 s10, s10, 12
    s_lshl_b32 s11, s42, 9
    s_add_u32 s10, s10, s11
    s_add_u32 s58, s58, s10
    s_add_u32 s58, s58, 16384
    s_waitcnt vmcnt(2)
    v_mfma_f32_32x32x16_bf16 v[64:79], v[160:163], v[8:11], 0
    v_mfma_f32_32x32x8_bf16 v[64:79], v[164:165], v[12:13], v[64:79]
    s_waitcnt vmcnt(0)
    v_mfma_f32_32x32x16_bf16 v[80:95], v[160:163], v[16:19], 0
    v_mfma_f32_32x32x8_bf16 v[80:95], v[164:165], v[20:21], v[80:95]
    s_nop 8
    v_max3_f32 v24, v64, v65, v24
    v_max3_f32 v24, v66, v67, v24
    v_max3_f32 v24, v68, v69, v24
    v_max3_f32 v24, v70, v71, v24
    v_max3_f32 v24, v72, v73, v24
    v_max3_f32 v24, v74, v75, v24
    v_max3_f32 v24, v76, v77, v24
    v_max3_f32 v24, v78, v79, v24
    v_mov_b32 v26, v24
    s_nop 1
    v_permlane32_swap_b32 v24, v26
    s_nop 1
    v_max_f32 v24, v24, v26
    v_sub_f32 v32, 0, v24
    v_sub_f32 v33, 0, v24
    v_sub_f32 v34, 0, v24
    v_sub_f32 v35, 0, v24
    v_sub_f32 v36, 0, v24
    v_sub_f32 v37, 0, v24
    v_sub_f32 v38, 0, v24
    v_sub_f32 v39, 0, v24
    v_sub_f32 v40, 0, v24
    v_sub_f32 v41, 0, v24
    v_sub_f32 v42, 0, v24
    v_sub_f32 v43, 0, v24
    v_sub_f32 v44, 0, v24
    v_sub_f32 v45, 0, v24
    v_sub_f32 v46, 0, v24
    v_sub_f32 v47, 0, v24
    s_nop 1
    v_mfma_f32_32x32x16_bf16 v[64:79], v[160:163], v[8:11], v[32:47]
    v_mfma_f32_32x32x8_bf16 v[64:79], v[164:165], v[12:13], v[64:79]
    v_max3_f32 v25, v80, v81, v25
    v_max3_f32 v25, v82, v83, v25
    v_max3_f32 v25, v84, v85, v25
    v_max3_f32 v25, v86, v87, v25
    v_max3_f32 v25, v88, v89, v25
    v_max3_f32 v25, v90, v91, v25
    v_max3_f32 v25, v92, v93, v25
    v_max3_f32 v25, v94, v95, v25
    v_mov_b32 v26, v25
    s_nop 1
    v_permlane32_swap_b32 v25, v26
    s_nop 1
    v_max_f32 v25, v25, v26
    v_sub_f32 v48, 0, v25
    v_sub_f32 v49, 0, v25
    v_sub_f32 v50, 0, v25
    v_sub_f32 v51, 0, v25
    v_sub_f32 v52, 0, v25
    v_sub_f32 v53, 0, v25
    v_sub_f32 v54, 0, v25
    v_sub_f32 v55, 0, v25
    v_sub_f32 v56, 0, v25
    v_sub_f32 v57, 0, v25
    v_sub_f32 v58, 0, v25
    v_sub_f32 v59, 0, v25
    v_sub_f32 v60, 0, v25
    v_sub_f32 v61, 0, v25
    v_sub_f32 v62, 0, v25
    v_sub_f32 v63, 0, v25
    s_barrier
    ds_read_b128 v[144:147], v22 offset:0
    ds_read_b128 v[152:155], v30 offset:0
    ds_read_b64 v[148:149], v23 offset:0
    ds_read_b128 v[156:159], v30 offset:768
.p2align 6
K2_loop:
    v_exp_f32 v64, v64
    v_exp_f32 v65, v65
    v_mfma_f32_32x32x16_bf16 v[80:95], v[160:163], v[16:19], v[48:63]
    s_waitcnt lgkmcnt(0)
    v_exp_f32 v66, v66
    v_exp_f32 v67, v67
    v_cvt_pk_bf16_f32 v96, v64, v65
    v_cvt_pk_bf16_f32 v97, v66, v67
    v_exp_f32 v68, v68
    v_exp_f32 v69, v69
    v_mfma_f32_32x32x8_bf16 v[80:95], v[164:165], v[20:21], v[80:95]
    v_exp_f32 v70, v70
    v_exp_f32 v71, v71
    v_cvt_pk_bf16_f32 v98, v68, v69
    v_cvt_pk_bf16_f32 v99, v70, v71
    v_exp_f32 v72, v72
    v_exp_f32 v73, v73
    v_mfma_f32_32x32x16_bf16 v[128:143], v[172:175], v[108:111], v[128:143]
    ds_read_b128 v[160:163], v22 offset:1536
    v_exp_f32 v74, v74
    v_exp_f32 v75, v75
    v_cvt_pk_bf16_f32 v100, v72, v73
    v_cvt_pk_bf16_f32 v101, v74, v75
    v_exp_f32 v76, v76
    v_exp_f32 v77, v77
    v_mfma_f32_32x32x16_bf16 v[112:127], v[152:155], v[96:99], v[112:127]
    ds_read_b128 v[168:171], v30 offset:1536
    v_exp_f32 v78, v78
    v_exp_f32 v79, v79
    v_cvt_pk_bf16_f32 v102, v76, v77
    v_cvt_pk_bf16_f32 v103, v78, v79
    v_exp_f32 v80, v80
    v_exp_f32 v81, v81
    v_mfma_f32_32x32x16_bf16 v[64:79], v[144:147], v[8:11], v[32:47]
    ds_read_b64 v[164:165], v23 offset:1536
    v_exp_f32 v82, v82
    v_exp_f32 v83, v83
    v_cvt_pk_bf16_f32 v104, v80, v81
    v_cvt_pk_bf16_f32 v105, v82, v83
    v_exp_f32 v84, v84
    v_exp_f32 v85, v85
    v_mfma_f32_32x32x8_bf16 v[64:79], v[148:149], v[12:13], v[64:79]
    v_exp_f32 v86, v86
    v_exp_f32 v87, v87
    v_cvt_pk_bf16_f32 v106, v84, v85
    v_cvt_pk_bf16_f32 v107, v86, v87
    v_exp_f32 v88, v88
    v_exp_f32 v89, v89
    v_mfma_f32_32x32x16_bf16 v[112:127], v[156:159], v[100:103], v[112:127]
    ds_read_b128 v[172:175], v30 offset:2304
    v_exp_f32 v90, v90
    v_exp_f32 v91, v91
    v_cvt_pk_bf16_f32 v108, v88, v89
    v_cvt_pk_bf16_f32 v109, v90, v91
    v_exp_f32 v92, v92
    v_exp_f32 v93, v93
    v_mfma_f32_32x32x16_bf16 v[128:143], v[152:155], v[104:107], v[128:143]
    v_exp_f32 v94, v94
    v_exp_f32 v95, v95
    v_cvt_pk_bf16_f32 v110, v92, v93
    v_cvt_pk_bf16_f32 v111, v94, v95
    v_exp_f32 v64, v64
    v_exp_f32 v65, v65
    v_mfma_f32_32x32x16_bf16 v[80:95], v[144:147], v[16:19], v[48:63]
    s_waitcnt lgkmcnt(0)
    v_exp_f32 v66, v66
    v_exp_f32 v67, v67
    v_cvt_pk_bf16_f32 v96, v64, v65
    v_cvt_pk_bf16_f32 v97, v66, v67
    v_exp_f32 v68, v68
    v_exp_f32 v69, v69
    v_mfma_f32_32x32x8_bf16 v[80:95], v[148:149], v[20:21], v[80:95]
    v_exp_f32 v70, v70
    v_exp_f32 v71, v71
    v_cvt_pk_bf16_f32 v98, v68, v69
    v_cvt_pk_bf16_f32 v99, v70, v71
    v_exp_f32 v72, v72
    v_exp_f32 v73, v73
    v_mfma_f32_32x32x16_bf16 v[128:143], v[156:159], v[108:111], v[128:143]
    ds_read_b128 v[144:147], v22 offset:3072
    v_exp_f32 v74, v74
    v_exp_f32 v75, v75
    v_cvt_pk_bf16_f32 v100, v72, v73
    v_cvt_pk_bf16_f32 v101, v74, v75
    v_exp_f32 v76, v76
    v_exp_f32 v77, v77
    v_mfma_f32_32x32x16_bf16 v[112:127], v[168:171], v[96:99], v[112:127]
    ds_read_b128 v[152:155], v30 offset:3072
    v_exp_f32 v78, v78
    v_exp_f32 v79, v79
    v_cvt_pk_bf16_f32 v102, v76, v77
    v_cvt_pk_bf16_f32 v103, v78, v79
    v_exp_f32 v80, v80
    v_exp_f32 v81, v81
    v_mfma_f32_32x32x16_bf16 v[64:79], v[160:163], v[8:11], v[32:47]
    ds_read_b64 v[148:149], v23 offset:3072
    v_exp_f32 v82, v82
    v_exp_f32 v83, v83
    v_cvt_pk_bf16_f32 v104, v80, v81
    v_cvt_pk_bf16_f32 v105, v82, v83
    v_exp_f32 v84, v84
    v_exp_f32 v85, v85
    v_mfma_f32_32x32x8_bf16 v[64:79], v[164:165], v[12:13], v[64:79]
    v_exp_f32 v86, v86
    v_exp_f32 v87, v87
    v_cvt_pk_bf16_f32 v106, v84, v85
    v_cvt_pk_bf16_f32 v107, v86, v87
    v_exp_f32 v88, v88
    v_exp_f32 v89, v89
    v_mfma_f32_32x32x16_bf16 v[112:127], v[172:175], v[100:103], v[112:127]
    ds_read_b128 v[156:159], v30 offset:3840
    v_exp_f32 v90, v90
    v_exp_f32 v91, v91
    v_cvt_pk_bf16_f32 v108, v88, v89
    v_cvt_pk_bf16_f32 v109, v90, v91
    v_exp_f32 v92, v92
    v_exp_f32 v93, v93
    v_mfma_f32_32x32x16_bf16 v[128:143], v[168:171], v[104:107], v[128:143]
    v_exp_f32 v94, v94
    v_exp_f32 v95, v95
    v_cvt_pk_bf16_f32 v110, v92, v93
    v_cvt_pk_bf16_f32 v111, v94, v95
    v_exp_f32 v64, v64
    v_exp_f32 v65, v65
    v_mfma_f32_32x32x16_bf16 v[80:95], v[160:163], v[16:19], v[48:63]
    s_waitcnt lgkmcnt(0)
    v_exp_f32 v66, v66
    v_exp_f32 v67, v67
    v_cvt_pk_bf16_f32 v96, v64, v65
    v_cvt_pk_bf16_f32 v97, v66, v67
    v_exp_f32 v68, v68
    v_exp_f32 v69, v69
    v_mfma_f32_32x32x8_bf16 v[80:95], v[164:165], v[20:21], v[80:95]
    v_exp_f32 v70, v70
    v_exp_f32 v71, v71
    v_cvt_pk_bf16_f32 v98, v68, v69
    v_cvt_pk_bf16_f32 v99, v70, v71
    v_exp_f32 v72, v72
    v_exp_f32 v73, v73
    v_mfma_f32_32x32x16_bf16 v[128:143], v[172:175], v[108:111], v[128:143]
    ds_read_b128 v[160:163], v22 offset:4608
    v_exp_f32 v74, v74
    v_exp_f32 v75, v75
    v_cvt_pk_bf16_f32 v100, v72, v73
    v_cvt_pk_bf16_f32 v101, v74, v75
    v_exp_f32 v76, v76
    v_exp_f32 v77, v77
    v_mfma_f32_32x32x16_bf16 v[112:127], v[152:155], v[96:99], v[112:127]
    ds_read_b128 v[168:171], v30 offset:4608
    v_exp_f32 v78, v78
    v_exp_f32 v79, v79
    v_cvt_pk_bf16_f32 v102, v76, v77
    v_cvt_pk_bf16_f32 v103, v78, v79
    v_exp_f32 v80, v80
    v_exp_f32 v81, v81
    v_mfma_f32_32x32x16_bf16 v[64:79], v[144:147], v[8:11], v[32:47]
    ds_read_b64 v[164:165], v23 offset:4608
    v_exp_f32 v82, v82
    v_exp_f32 v83, v83
    v_cvt_pk_bf16_f32 v104, v80, v81
    v_cvt_pk_bf16_f32 v105, v82, v83
    v_exp_f32 v84, v84
    v_exp_f32 v85, v85
    v_mfma_f32_32x32x8_bf16 v[64:79], v[148:149], v[12:13], v[64:79]
    v_exp_f32 v86, v86
    v_exp_f32 v87, v87
    v_cvt_pk_bf16_f32 v106, v84, v85
    v_cvt_pk_bf16_f32 v107, v86, v87
    v_exp_f32 v88, v88
    v_exp_f32 v89, v89
    v_mfma_f32_32x32x16_bf16 v[112:127], v[156:159], v[100:103], v[112:127]
    ds_read_b128 v[172:175], v30 offset:5376
    v_exp_f32 v90, v90
    v_exp_f32 v91, v91
    v_cvt_pk_bf16_f32 v108, v88, v89
    v_cvt_pk_bf16_f32 v109, v90, v91
    v_exp_f32 v92, v92
    v_exp_f32 v93, v93
    v_mfma_f32_32x32x16_bf16 v[128:143], v[152:155], v[104:107], v[128:143]
    s_add_u32 s36, s36, 1
    v_exp_f32 v94, v94
    v_exp_f32 v95, v95
    v_cvt_pk_bf16_f32 v110, v92, v93
    v_cvt_pk_bf16_f32 v111, v94, v95
    v_exp_f32 v64, v64
    v_exp_f32 v65, v65
    v_mfma_f32_32x32x16_bf16 v[80:95], v[144:147], v[16:19], v[48:63]
    s_waitcnt lgkmcnt(0)
    v_exp_f32 v66, v66
    v_exp_f32 v67, v67
    v_cvt_pk_bf16_f32 v96, v64, v65
    v_cvt_pk_bf16_f32 v97, v66, v67
    v_exp_f32 v68, v68
    v_exp_f32 v69, v69
    v_mfma_f32_32x32x8_bf16 v[80:95], v[148:149], v[20:21], v[80:95]
    v_exp_f32 v70, v70
    v_exp_f32 v71, v71
    v_cvt_pk_bf16_f32 v98, v68, v69
    v_cvt_pk_bf16_f32 v99, v70, v71
    v_exp_f32 v72, v72
    v_exp_f32 v73, v73
    v_mfma_f32_32x32x16_bf16 v[128:143], v[156:159], v[108:111], v[128:143]
    ds_read_b128 v[144:147], v22 offset:6144
    v_exp_f32 v74, v74
    v_exp_f32 v75, v75
    v_cvt_pk_bf16_f32 v100, v72, v73
    v_cvt_pk_bf16_f32 v101, v74, v75
    v_exp_f32 v76, v76
    v_exp_f32 v77, v77
    v_mfma_f32_32x32x16_bf16 v[112:127], v[168:171], v[96:99], v[112:127]
    ds_read_b128 v[152:155], v30 offset:6144
    v_exp_f32 v78, v78
    v_exp_f32 v79, v79
    v_cvt_pk_bf16_f32 v102, v76, v77
    v_cvt_pk_bf16_f32 v103, v78, v79
    v_exp_f32 v80, v80
    v_exp_f32 v81, v81
    v_mfma_f32_32x32x16_bf16 v[64:79], v[160:163], v[8:11], v[32:47]
    ds_read_b64 v[148:149], v23 offset:6144
    v_exp_f32 v82, v82
    v_exp_f32 v83, v83
    v_cvt_pk_bf16_f32 v104, v80, v81
    v_cvt_pk_bf16_f32 v105, v82, v83
    v_exp_f32 v84, v84
    v_exp_f32 v85, v85
    v_mfma_f32_32x32x8_bf16 v[64:79], v[164:165], v[12:13], v[64:79]
    v_exp_f32 v86, v86
    v_exp_f32 v87, v87
    v_cvt_pk_bf16_f32 v106, v84, v85
    v_cvt_pk_bf16_f32 v107, v86, v87
    v_exp_f32 v88, v88
    v_exp_f32 v89, v89
    v_mfma_f32_32x32x16_bf16 v[112:127], v[172:175], v[100:103], v[112:127]
    ds_read_b128 v[156:159], v30 offset:6912
    v_exp_f32 v90, v90
    v_exp_f32 v91, v91
    v_cvt_pk_bf16_f32 v108, v88, v89
    v_cvt_pk_bf16_f32 v109, v90, v91
    v_exp_f32 v92, v92
    v_exp_f32 v93, v93
    v_mfma_f32_32x32x16_bf16 v[128:143], v[168:171], v[104:107], v[128:143]
    s_add_u32 s37, s37, 1
    v_exp_f32 v94, v94
    v_exp_f32 v95, v95
    v_cvt_pk_bf16_f32 v110, v92, v93
    v_cvt_pk_bf16_f32 v111, v94, v95
    v_exp_f32 v64, v64
    v_exp_f32 v65, v65
    v_mfma_f32_32x32x16_bf16 v[80:95], v[160:163], v[16:19], v[48:63]
    s_waitcnt lgkmcnt(0)
    v_exp_f32 v66, v66
    v_exp_f32 v67, v67
    v_cvt_pk_bf16_f32 v96, v64, v65
    v_cvt_pk_bf16_f32 v97, v66, v67
    v_exp_f32 v68, v68
    v_exp_f32 v69, v69
    v_mfma_f32_32x32x8_bf16 v[80:95], v[164:165], v[20:21], v[80:95]
    v_exp_f32 v70, v70
    v_exp_f32 v71, v71
    v_cvt_pk_bf16_f32 v98, v68, v69
    v_cvt_pk_bf16_f32 v99, v70, v71
    v_exp_f32 v72, v72
    v_exp_f32 v73, v73
    v_mfma_f32_32x32x16_bf16 v[128:143], v[172:175], v[108:111], v[128:143]
    ds_read_b128 v[160:163], v22 offset:7680
    v_exp_f32 v74, v74
    v_exp_f32 v75, v75
    v_cvt_pk_bf16_f32 v100, v72, v73
    v_cvt_pk_bf16_f32 v101, v74, v75
    v_exp_f32 v76, v76
    v_exp_f32 v77, v77
    v_mfma_f32_32x32x16_bf16 v[112:127], v[152:155], v[96:99], v[112:127]
    ds_read_b128 v[168:171], v30 offset:7680
    v_exp_f32 v78, v78
    v_exp_f32 v79, v79
    v_cvt_pk_bf16_f32 v102, v76, v77
    v_cvt_pk_bf16_f32 v103, v78, v79
    v_exp_f32 v80, v80
    v_exp_f32 v81, v81
    v_mfma_f32_32x32x16_bf16 v[64:79], v[144:147], v[8:11], v[32:47]
    ds_read_b64 v[164:165], v23 offset:7680
    v_exp_f32 v82, v82
    v_exp_f32 v83, v83
    v_cvt_pk_bf16_f32 v104, v80, v81
    v_cvt_pk_bf16_f32 v105, v82, v83
    v_exp_f32 v84, v84
    v_exp_f32 v85, v85
    v_mfma_f32_32x32x8_bf16 v[64:79], v[148:149], v[12:13], v[64:79]
    v_exp_f32 v86, v86
    v_exp_f32 v87, v87
    v_cvt_pk_bf16_f32 v106, v84, v85
    v_cvt_pk_bf16_f32 v107, v86, v87
    v_exp_f32 v88, v88
    v_exp_f32 v89, v89
    v_mfma_f32_32x32x16_bf16 v[112:127], v[156:159], v[100:103], v[112:127]
    ds_read_b128 v[172:175], v30 offset:8448
    v_exp_f32 v90, v90
    v_exp_f32 v91, v91
    v_cvt_pk_bf16_f32 v108, v88, v89
    v_cvt_pk_bf16_f32 v109, v90, v91
    v_exp_f32 v92, v92
    v_exp_f32 v93, v93
    v_mfma_f32_32x32x16_bf16 v[128:143], v[152:155], v[104:107], v[128:143]
    s_cmp_eq_u32 s37, 3
    v_exp_f32 v94, v94
    v_exp_f32 v95, v95
    v_cvt_pk_bf16_f32 v110, v92, v93
    v_cvt_pk_bf16_f32 v111, v94, v95
    v_exp_f32 v64, v64
    v_exp_f32 v65, v65
    v_mfma_f32_32x32x16_bf16 v[80:95], v[144:147], v[16:19], v[48:63]
    s_waitcnt lgkmcnt(0)
    v_exp_f32 v66, v66
    v_exp_f32 v67, v67
    v_cvt_pk_bf16_f32 v96, v64, v65
    v_cvt_pk_bf16_f32 v97, v66, v67
    v_exp_f32 v68, v68
    v_exp_f32 v69, v69
    v_mfma_f32_32x32x8_bf16 v[80:95], v[148:149], v[20:21], v[80:95]
    v_exp_f32 v70, v70
    v_exp_f32 v71, v71
    v_cvt_pk_bf16_f32 v98, v68, v69
    v_cvt_pk_bf16_f32 v99, v70, v71
    v_exp_f32 v72, v72
    v_exp_f32 v73, v73
    v_mfma_f32_32x32x16_bf16 v[128:143], v[156:159], v[108:111], v[128:143]
    ds_read_b128 v[144:147], v22 offset:9216
    v_exp_f32 v74, v74
    v_exp_f32 v75, v75
    v_cvt_pk_bf16_f32 v100, v72, v73
    v_cvt_pk_bf16_f32 v101, v74, v75
    v_exp_f32 v76, v76
    v_exp_f32 v77, v77
    v_mfma_f32_32x32x16_bf16 v[112:127], v[168:171], v[96:99], v[112:127]
    ds_read_b128 v[152:155], v30 offset:9216
    v_exp_f32 v78, v78
    v_exp_f32 v79, v79
    v_cvt_pk_bf16_f32 v102, v76, v77
    v_cvt_pk_bf16_f32 v103, v78, v79
    v_exp_f32 v80, v80
    v_exp_f32 v81, v81
    v_mfma_f32_32x32x16_bf16 v[64:79], v[160:163], v[8:11], v[32:47]
    ds_read_b64 v[148:149], v23 offset:9216
    v_exp_f32 v82, v82
    v_exp_f32 v83, v83
    v_cvt_pk_bf16_f32 v104, v80, v81
    v_cvt_pk_bf16_f32 v105, v82, v83
    v_exp_f32 v84, v84
    v_exp_f32 v85, v85
    v_mfma_f32_32x32x8_bf16 v[64:79], v[164:165], v[12:13], v[64:79]
    v_exp_f32 v86, v86
    v_exp_f32 v87, v87
    v_cvt_pk_bf16_f32 v106, v84, v85
    v_cvt_pk_bf16_f32 v107, v86, v87
    v_exp_f32 v88, v88
    v_exp_f32 v89, v89
    v_mfma_f32_32x32x16_bf16 v[112:127], v[172:175], v[100:103], v[112:127]
    ds_read_b128 v[156:159], v30 offset:9984
    v_exp_f32 v90, v90
    v_exp_f32 v91, v91
    v_cvt_pk_bf16_f32 v108, v88, v89
    v_cvt_pk_bf16_f32 v109, v90, v91
    v_exp_f32 v92, v92
    v_exp_f32 v93, v93
    v_mfma_f32_32x32x16_bf16 v[128:143], v[168:171], v[104:107], v[128:143]
    s_cselect_b32 s40, 4294918144, s41
    v_exp_f32 v94, v94
    v_exp_f32 v95, v95
    v_cvt_pk_bf16_f32 v110, v92, v93
    v_cvt_pk_bf16_f32 v111, v94, v95
    v_exp_f32 v64, v64
    v_exp_f32 v65, v65
    v_mfma_f32_32x32x16_bf16 v[80:95], v[160:163], v[16:19], v[48:63]
    s_waitcnt lgkmcnt(0)
    v_exp_f32 v66, v66
    v_exp_f32 v67, v67
    v_cvt_pk_bf16_f32 v96, v64, v65
    v_cvt_pk_bf16_f32 v97, v66, v67
    v_exp_f32 v68, v68
    v_exp_f32 v69, v69
    v_mfma_f32_32x32x8_bf16 v[80:95], v[164:165], v[20:21], v[80:95]
    v_exp_f32 v70, v70
    v_exp_f32 v71, v71
    v_cvt_pk_bf16_f32 v98, v68, v69
    v_cvt_pk_bf16_f32 v99, v70, v71
    v_exp_f32 v72, v72
    v_exp_f32 v73, v73
    v_mfma_f32_32x32x16_bf16 v[128:143], v[172:175], v[108:111], v[128:143]
    ds_read_b128 v[160:163], v22 offset:10752
    v_exp_f32 v74, v74
    v_exp_f32 v75, v75
    v_cvt_pk_bf16_f32 v100, v72, v73
    v_cvt_pk_bf16_f32 v101, v74, v75
    v_exp_f32 v76, v76
    v_exp_f32 v77, v77
    v_mfma_f32_32x32x16_bf16 v[112:127], v[152:155], v[96:99], v[112:127]
    ds_read_b128 v[168:171], v30 offset:10752
    v_exp_f32 v78, v78
    v_exp_f32 v79, v79
    v_cvt_pk_bf16_f32 v102, v76, v77
    v_cvt_pk_bf16_f32 v103, v78, v79
    v_exp_f32 v80, v80
    v_exp_f32 v81, v81
    v_mfma_f32_32x32x16_bf16 v[64:79], v[144:147], v[8:11], v[32:47]
    ds_read_b64 v[164:165], v23 offset:10752
    v_exp_f32 v82, v82
    v_exp_f32 v83, v83
    v_cvt_pk_bf16_f32 v104, v80, v81
    v_cvt_pk_bf16_f32 v105, v82, v83
    v_exp_f32 v84, v84
    v_exp_f32 v85, v85
    v_mfma_f32_32x32x8_bf16 v[64:79], v[148:149], v[12:13], v[64:79]
    v_exp_f32 v86, v86
    v_exp_f32 v87, v87
    v_cvt_pk_bf16_f32 v106, v84, v85
    v_cvt_pk_bf16_f32 v107, v86, v87
    v_exp_f32 v88, v88
    v_exp_f32 v89, v89
    v_mfma_f32_32x32x16_bf16 v[112:127], v[156:159], v[100:103], v[112:127]
    ds_read_b128 v[172:175], v30 offset:11520
    v_exp_f32 v90, v90
    v_exp_f32 v91, v91
    v_cvt_pk_bf16_f32 v108, v88, v89
    v_cvt_pk_bf16_f32 v109, v90, v91
    v_exp_f32 v92, v92
    v_exp_f32 v93, v93
    v_mfma_f32_32x32x16_bf16 v[128:143], v[152:155], v[104:107], v[128:143]
    s_cselect_b32 s37, 0, s37
    v_exp_f32 v94, v94
    v_exp_f32 v95, v95
    v_cvt_pk_bf16_f32 v110, v92, v93
    v_cvt_pk_bf16_f32 v111, v94, v95
    v_exp_f32 v64, v64
    v_exp_f32 v65, v65
    v_mfma_f32_32x32x16_bf16 v[80:95], v[144:147], v[16:19], v[48:63]
    s_waitcnt lgkmcnt(0)
    s_barrier
    v_exp_f32 v66, v66
    v_exp_f32 v67, v67
    v_cvt_pk_bf16_f32 v96, v64, v65
    v_cvt_pk_bf16_f32 v97, v66, v67
    v_exp_f32 v68, v68
    v_exp_f32 v69, v69
    v_mfma_f32_32x32x8_bf16 v[80:95], v[148:149], v[20:21], v[80:95]
    v_add_u32 v22, s40, v22
    v_add_u32 v23, s40, v23
    v_add_u32 v30, s40, v30
    v_exp_f32 v70, v70
    v_exp_f32 v71, v71
    v_cvt_pk_bf16_f32 v98, v68, v69
    v_cvt_pk_bf16_f32 v99, v70, v71
    v_exp_f32 v72, v72
    v_exp_f32 v73, v73
    v_mfma_f32_32x32x16_bf16 v[128:143], v[156:159], v[108:111], v[128:143]
    ds_read_b128 v[144:147], v22 offset:0
    v_exp_f32 v74, v74
    v_exp_f32 v75, v75
    v_cvt_pk_bf16_f32 v100, v72, v73
    v_cvt_pk_bf16_f32 v101, v74, v75
    v_exp_f32 v76, v76
    v_exp_f32 v77, v77
    v_mfma_f32_32x32x16_bf16 v[112:127], v[168:171], v[96:99], v[112:127]
    ds_read_b128 v[152:155], v30 offset:0
    v_exp_f32 v78, v78
    v_exp_f32 v79, v79
    v_cvt_pk_bf16_f32 v102, v76, v77
    v_cvt_pk_bf16_f32 v103, v78, v79
    v_exp_f32 v80, v80
    v_exp_f32 v81, v81
    v_mfma_f32_32x32x16_bf16 v[64:79], v[160:163], v[8:11], v[32:47]
    ds_read_b64 v[148:149], v23 offset:0
    v_exp_f32 v82, v82
    v_exp_f32 v83, v83
    v_cvt_pk_bf16_f32 v104, v80, v81
    v_cvt_pk_bf16_f32 v105, v82, v83
    v_exp_f32 v84, v84
    v_exp_f32 v85, v85
    v_mfma_f32_32x32x8_bf16 v[64:79], v[164:165], v[12:13], v[64:79]
    v_exp_f32 v86, v86
    v_exp_f32 v87, v87
    v_cvt_pk_bf16_f32 v106, v84, v85
    v_cvt_pk_bf16_f32 v107, v86, v87
    v_exp_f32 v88, v88
    v_exp_f32 v89, v89
    v_mfma_f32_32x32x16_bf16 v[112:127], v[172:175], v[100:103], v[112:127]
    ds_read_b128 v[156:159], v30 offset:768
    v_exp_f32 v90, v90
    v_exp_f32 v91, v91
    v_cvt_pk_bf16_f32 v108, v88, v89
    v_cvt_pk_bf16_f32 v109, v90, v91
    v_exp_f32 v92, v92
    v_exp_f32 v93, v93
    v_mfma_f32_32x32x16_bf16 v[128:143], v[168:171], v[104:107], v[128:143]
    s_cmp_lt_u32 s36, 8
    v_exp_f32 v94, v94
    v_exp_f32 v95, v95
    v_cvt_pk_bf16_f32 v110, v92, v93
    v_cvt_pk_bf16_f32 v111, v94, v95
    s_cbranch_scc1 K2_loop
    s_nop 0
    v_mfma_f32_32x32x16_bf16 v[128:143], v[172:175], v[108:111], v[128:143]
K2_out:
    v_mov_b32 v26, v120
    v_mov_b32 v27, v120
    s_nop 1
    v_permlane32_swap_b32 v27, v26
    s_nop 0
    v_rcp_f32 v26, v26
    s_nop 0
    v_mul_f32 v32, v112, v26
    v_mul_f32 v33, v113, v26
    v_mul_f32 v34, v114, v26
    v_mul_f32 v35, v115, v26
    v_mul_f32 v36, v116, v26
    v_mul_f32 v37, v117, v26
    v_mul_f32 v38, v118, v26
    v_mul_f32 v39, v119, v26
    v_mul_f32 v40, v120, v26
    v_mul_f32 v41, v121, v26
    v_mul_f32 v42, v122, v26
    v_mul_f32 v43, v123, v26
    v_cvt_pk_bf16_f32 v32, v32, v33
    v_cvt_pk_bf16_f32 v33, v34, v35
    v_cvt_pk_bf16_f32 v34, v36, v37
    v_cvt_pk_bf16_f32 v35, v38, v39
    v_cvt_pk_bf16_f32 v36, v40, v41
    v_cvt_pk_bf16_f32 v37, v42, v43
    buffer_store_dwordx4 v[32:35], v28, s[24:27], s58 offen offset:0 sc1
    buffer_store_dwordx2 v[36:37], v29, s[24:27], s59 offen offset:0 sc1
    v_mov_b32 v26, v136
    v_mov_b32 v27, v136
    s_nop 1
    v_permlane32_swap_b32 v27, v26
    s_nop 0
    v_rcp_f32 v26, v26
    s_nop 0
    v_mul_f32 v48, v128, v26
    v_mul_f32 v49, v129, v26
    v_mul_f32 v50, v130, v26
    v_mul_f32 v51, v131, v26
    v_mul_f32 v52, v132, v26
    v_mul_f32 v53, v133, v26
    v_mul_f32 v54, v134, v26
    v_mul_f32 v55, v135, v26
    v_mul_f32 v56, v136, v26
    v_mul_f32 v57, v137, v26
    v_mul_f32 v58, v138, v26
    v_mul_f32 v59, v139, v26
    v_cvt_pk_bf16_f32 v48, v48, v49
    v_cvt_pk_bf16_f32 v49, v50, v51
    v_cvt_pk_bf16_f32 v50, v52, v53
    v_cvt_pk_bf16_f32 v51, v54, v55
    v_cvt_pk_bf16_f32 v52, v56, v57
    v_cvt_pk_bf16_f32 v53, v58, v59
    buffer_store_dwordx4 v[48:51], v28, s[24:27], s58 offen offset:2048 sc1
    buffer_store_dwordx2 v[52:53], v29, s[24:27], s59 offen offset:2048 sc1
    v_add_f32 v26, abs(v112), abs(v128)
    v_add_f32 v27, abs(v113), abs(v129)
    v_add_f32 v26, v26, v27
    v_add_f32 v27, abs(v114), abs(v130)
    v_add_f32 v26, v26, v27
    v_add_f32 v27, abs(v115), abs(v131)
    v_add_f32 v26, v26, v27
    v_add_f32 v27, abs(v116), abs(v132)
    v_add_f32 v26, v26, v27
    v_add_f32 v27, abs(v117), abs(v133)
    v_add_f32 v26, v26, v27
    v_add_f32 v27, abs(v118), abs(v134)
    v_add_f32 v26, v26, v27
    v_add_f32 v27, abs(v119), abs(v135)
    v_add_f32 v26, v26, v27
    v_add_f32 v27, abs(v120), abs(v136)
    v_add_f32 v26, v26, v27
    v_add_f32 v27, abs(v121), abs(v137)
    v_add_f32 v26, v26, v27
    v_add_f32 v27, abs(v122), abs(v138)
    v_add_f32 v26, v26, v27
    v_add_f32 v27, abs(v123), abs(v139)
    v_add_f32 v26, v26, v27
    s_movk_i32 s10, 0x207
    v_cmp_class_f32 vcc, v26, s10
    s_cmp_lg_u32 s35, 0
    s_cbranch_scc1 K2_ok
    s_cmp_lg_u64 vcc, 0
    s_cbranch_scc1 K2_slow
K2_ok:
    v_lshlrev_b32 v2, 4, v0
    s_and_b32 s36, s28, 1
    s_lshr_b32 s37, s28, 1
    s_lshl_b32 s10, s36, 11
    s_lshl_b32 s11, s37, 12
    s_add_u32 s10, s10, s11
    v_add_u32 v8, s10, v2
    s_mul_i32 s10, s37, 5120
    v_add_u32 v9, s10, v2
    s_mov_b32 s34, 0
    s_mov_b32 s35, 49152
    v_add_u32 v3, s34, v8
    v_add_u32 v4, s35, v9
    s_mov_b32 s33, 0
    v_and_b32 v5, 15, v0
    v_lshrrev_b32 v6, 4, v0
    s_mul_i32 s10, s36, 20480
    s_add_u32 s10, s10, 131072
    v_add_u32 v7, s10, v2
    s_lshl_b32 s10, s36, 5
    v_add_u32 v10, s10, v5
    v_mul_u32_u24 v10, 160, v10
    v_lshl_add_u32 v10, v6, 3, v10
    s_lshl_b32 s10, s37, 6
    s_add_u32 s10, s10, 151552
    v_add_u32 v10, s10, v10
    s_lshr_b32 s10, s56, 1
    s_mul_i32 s44, s10, 163840
    s_and_b32 s10, s56, 1
    s_lshl_b32 s10, s10, 12
    s_add_u32 s44, s44, s10
    s_lshl_b32 s10, s36, 11
    s_add_u32 s44, s44, s10
    s_add_u32 s44, s44, 11010048
    s_mul_i32 s45, s57, 5
    s_lshl_b32 s10, s37, 1
    s_add_u32 s45, s45, s10
    v_and_b32 v12, 1, v6
    v_lshlrev_b32 v12, 10, v12
    v_lshrrev_b32 v13, 1, v6
    v_lshl_add_u32 v12, v13, 8, v12
    v_lshl_add_u32 v12, v5, 4, v12
    v_lshlrev_b32 v14, 3, v5
    v_sub_u32 v14, v3, v14
    v_add_u32 v15, 8192, v14
    s_mov_b32 s40, 0x3f803f80
    v_mov_b32 v56, 0
    v_mov_b32 v57, 0
    v_mov_b32 v58, 0
    v_mov_b32 v59, 0
    v_lshlrev_b32 v11, 3, v5
    v_lshl_add_u32 v11, v6, 28, v11
    s_lshl_b32 s10, s56, 13
    s_lshl_b32 s11, s36, 12
    s_add_u32 s10, s10, s11
    s_lshl_b32 s11, s57, 8
    s_add_u32 s10, s10, s11
    s_lshl_b32 s11, s37, 7
    s_add_u32 s10, s10, s11
    s_add_u32 s49, s10, 19988480
    s_add_u32 s10, s45, 0
    s_lshr_b32 s11, s10, 1
    s_lshl_b32 s11, s11, 13
    s_and_b32 s10, s10, 1
    s_lshl_b32 s10, s10, 9
    s_add_u32 s46, s44, s11
    s_add_u32 s46, s46, s10
    s_add_u32 s10, s45, 1
    s_lshr_b32 s11, s10, 1
    s_lshl_b32 s11, s11, 13
    s_and_b32 s10, s10, 1
    s_lshl_b32 s10, s10, 9
    s_add_u32 s47, s44, s11
    s_add_u32 s47, s47, s10
    s_add_u32 s10, s45, 2
    s_lshr_b32 s11, s10, 1
    s_lshl_b32 s11, s11, 13
    s_and_b32 s10, s10, 1
    s_lshl_b32 s10, s10, 9
    s_add_u32 s48, s44, s11
    s_add_u32 s48, s48, s10
    s_waitcnt vmcnt(0)
    s_barrier
    ds_read_b64 v[232:233], v10 offset:0
    ds_read_b64 v[234:235], v10 offset:2560
    ds_read_b64 v[236:237], v10 offset:32
    ds_read_b64 v[238:239], v10 offset:2592
    ds_read_b64 v[240:241], v10 offset:64
    ds_read_b64 v[242:243], v10 offset:2624
    v_mov_b32 v16, 0
    v_mov_b32 v17, 0
    v_mov_b32 v18, 0
    v_mov_b32 v19, 0
    v_mov_b32 v20, 0
    v_mov_b32 v21, 0
    v_mov_b32 v22, 0
    v_mov_b32 v23, 0
    v_mov_b32 v24, 0
    v_mov_b32 v25, 0
    v_mov_b32 v26, 0
    v_mov_b32 v27, 0
    v_mov_b32 v28, 0
    v_mov_b32 v29, 0
    v_mov_b32 v30, 0
    v_mov_b32 v31, 0
    v_mov_b32 v32, 0
    v_mov_b32 v33, 0
    v_mov_b32 v34, 0
    v_mov_b32 v35, 0
    v_mov_b32 v36, 0
    v_mov_b32 v37, 0
    v_mov_b32 v38, 0
    v_mov_b32 v39, 0
    v_mov_b32 v40, 0
    v_mov_b32 v41, 0
    v_mov_b32 v42, 0
    v_mov_b32 v43, 0
    v_mov_b32 v44, 0
    v_mov_b32 v45, 0
    v_mov_b32 v46, 0
    v_mov_b32 v47, 0
    v_mov_b32 v48, 0
    v_mov_b32 v49, 0
    v_mov_b32 v50, 0
    v_mov_b32 v51, 0
    v_mov_b32 v52, 0
    v_mov_b32 v53, 0
    v_mov_b32 v54, 0
    v_mov_b32 v55, 0
    s_waitcnt lgkmcnt(0)
    s_cmp_eq_u32 s37, 1
    s_cbranch_scc1 WO_i3
    v_lshlrev_b32 v16, 16, v232
    v_and_b32 v17, 0xffff0000, v232
    v_lshlrev_b32 v18, 16, v233
    v_and_b32 v19, 0xffff0000, v233
    v_lshlrev_b32 v36, 16, v234
    v_and_b32 v37, 0xffff0000, v234
    v_lshlrev_b32 v38, 16, v235
    v_and_b32 v39, 0xffff0000, v235
    v_lshlrev_b32 v20, 16, v236
    v_and_b32 v21, 0xffff0000, v236
    v_lshlrev_b32 v22, 16, v237
    v_and_b32 v23, 0xffff0000, v237
    v_lshlrev_b32 v40, 16, v238
    v_and_b32 v41, 0xffff0000, v238
    v_lshlrev_b32 v42, 16, v239
    v_and_b32 v43, 0xffff0000, v239
    s_branch WO_ie
WO_i3:
    v_lshlrev_b32 v24, 16, v232
    v_and_b32 v25, 0xffff0000, v232
    v_lshlrev_b32 v26, 16, v233
    v_and_b32 v27, 0xffff0000, v233
    v_lshlrev_b32 v44, 16, v234
    v_and_b32 v45, 0xffff0000, v234
    v_lshlrev_b32 v46, 16, v235
    v_and_b32 v47, 0xffff0000, v235
    v_lshlrev_b32 v28, 16, v236
    v_and_b32 v29, 0xffff0000, v236
    v_lshlrev_b32 v30, 16, v237
    v_and_b32 v31, 0xffff0000, v237
    v_lshlrev_b32 v48, 16, v238
    v_and_b32 v49, 0xffff0000, v238
    v_lshlrev_b32 v50, 16, v239
    v_and_b32 v51, 0xffff0000, v239
    v_lshlrev_b32 v32, 16, v240
    v_and_b32 v33, 0xffff0000, v240
    v_lshlrev_b32 v34, 16, v241
    v_and_b32 v35, 0xffff0000, v241
    v_lshlrev_b32 v52, 16, v242
    v_and_b32 v53, 0xffff0000, v242
    v_lshlrev_b32 v54, 16, v243
    v_and_b32 v55, 0xffff0000, v243
WO_ie:
    s_barrier
    s_barrier
    ds_read2_b64 v[64:67], v14 offset0:0 offset1:16
    ds_read_b128 v[72:75], v4
    ds_read2_b64 v[68:71], v14 offset0:128 offset1:144
    ds_read_b128 v[76:79], v4 offset:1024
    ds_read_b128 v[80:83], v4 offset:2048
    ds_read_b128 v[84:87], v4 offset:3072
    ds_read_b128 v[88:91], v4 offset:4096
    s_add_u32 s34, s34, 8192
    s_cmp_eq_u32 s34, 49152
    s_cselect_b32 s34, 0, s34
    s_add_u32 s35, s35, 10240
    s_cmp_eq_u32 s35, 151552
    s_cselect_b32 s35, 49152, s35
    v_add_u32 v3, s34, v8
    v_add_u32 v4, s35, v9
    s_waitcnt lgkmcnt(0)
    v_mfma_f32_16x16x32_bf16 v[16:19], v[72:75], v[64:67], v[16:19]
    s_barrier
    v_mfma_f32_16x16x32_bf16 v[36:39], v[72:75], v[68:71], v[36:39]
    ds_read2_b64 v[92:95], v15 offset0:0 offset1:16
    ds_read_b128 v[100:103], v4
    v_mfma_f32_16x16x32_bf16 v[20:23], v[76:79], v[64:67], v[20:23]
    ds_read2_b64 v[96:99], v15 offset0:128 offset1:144
    ds_read_b128 v[104:107], v4 offset:1024
    v_mfma_f32_16x16x32_bf16 v[40:43], v[76:79], v[68:71], v[40:43]
    ds_read_b128 v[108:111], v4 offset:2048
    ds_read_b128 v[112:115], v4 offset:3072
    v_mfma_f32_16x16x32_bf16 v[24:27], v[80:83], v[64:67], v[24:27]
    ds_read_b128 v[116:119], v4 offset:4096
    s_add_u32 s34, s34, 8192
    v_mfma_f32_16x16x32_bf16 v[44:47], v[80:83], v[68:71], v[44:47]
    s_cmp_eq_u32 s34, 49152
    s_cselect_b32 s34, 0, s34
    v_mfma_f32_16x16x32_bf16 v[28:31], v[84:87], v[64:67], v[28:31]
    s_add_u32 s35, s35, 10240
    s_cmp_eq_u32 s35, 151552
    v_mfma_f32_16x16x32_bf16 v[48:51], v[84:87], v[68:71], v[48:51]
    s_cselect_b32 s35, 49152, s35
    v_add_u32 v3, s34, v8
    v_mfma_f32_16x16x32_bf16 v[32:35], v[88:91], v[64:67], v[32:35]
    v_add_u32 v4, s35, v9
    s_add_u32 s33, s33, 2
    v_mfma_f32_16x16x32_bf16 v[52:55], v[88:91], v[68:71], v[52:55]
    s_cmp_eq_u32 s33, 10
    s_branch WO_mid
WO_loop:
    s_waitcnt lgkmcnt(0)
    v_mfma_f32_16x16x32_bf16 v[16:19], v[72:75], v[64:67], v[16:19]
    s_barrier
    v_mfma_f32_16x16x32_bf16 v[36:39], v[72:75], v[68:71], v[36:39]
    ds_read_b128 v[92:95], v3
    ds_read_b128 v[100:103], v4
    v_mfma_f32_16x16x32_bf16 v[20:23], v[76:79], v[64:67], v[20:23]
    ds_read_b128 v[96:99], v3 offset:1024
    ds_read_b128 v[104:107], v4 offset:1024
    v_mfma_f32_16x16x32_bf16 v[40:43], v[76:79], v[68:71], v[40:43]
    ds_read_b128 v[108:111], v4 offset:2048
    ds_read_b128 v[112:115], v4 offset:3072
    v_mfma_f32_16x16x32_bf16 v[24:27], v[80:83], v[64:67], v[24:27]
    ds_read_b128 v[116:119], v4 offset:4096
    s_add_u32 s34, s34, 8192
    v_mfma_f32_16x16x32_bf16 v[44:47], v[80:83], v[68:71], v[44:47]
    s_cmp_eq_u32 s34, 49152
    s_cselect_b32 s34, 0, s34
    v_mfma_f32_16x16x32_bf16 v[28:31], v[84:87], v[64:67], v[28:31]
    s_add_u32 s35, s35, 10240
    s_cmp_eq_u32 s35, 151552
    v_mfma_f32_16x16x32_bf16 v[48:51], v[84:87], v[68:71], v[48:51]
    s_cselect_b32 s35, 49152, s35
    v_add_u32 v3, s34, v8
    v_mfma_f32_16x16x32_bf16 v[32:35], v[88:91], v[64:67], v[32:35]
    v_add_u32 v4, s35, v9
    s_add_u32 s33, s33, 2
    v_mfma_f32_16x16x32_bf16 v[52:55], v[88:91], v[68:71], v[52:55]
    s_cmp_eq_u32 s33, 10
WO_mid:
    s_waitcnt lgkmcnt(0)
    s_cbranch_scc1 WO_last
    v_mfma_f32_16x16x32_bf16 v[16:19], v[100:103], v[92:95], v[16:19]
    s_barrier
    v_mfma_f32_16x16x32_bf16 v[36:39], v[100:103], v[96:99], v[36:39]
    ds_read_b128 v[64:67], v3
    ds_read_b128 v[72:75], v4
    v_mfma_f32_16x16x32_bf16 v[20:23], v[104:107], v[92:95], v[20:23]
    ds_read_b128 v[68:71], v3 offset:1024
    ds_read_b128 v[76:79], v4 offset:1024
    v_mfma_f32_16x16x32_bf16 v[40:43], v[104:107], v[96:99], v[40:43]
    ds_read_b128 v[80:83], v4 offset:2048
    ds_read_b128 v[84:87], v4 offset:3072
    v_mfma_f32_16x16x32_bf16 v[24:27], v[108:111], v[92:95], v[24:27]
    ds_read_b128 v[88:91], v4 offset:4096
    s_add_u32 s34, s34, 8192
    v_mfma_f32_16x16x32_bf16 v[44:47], v[108:111], v[96:99], v[44:47]
    s_cmp_eq_u32 s34, 49152
    s_cselect_b32 s34, 0, s34
    v_mfma_f32_16x16x32_bf16 v[28:31], v[112:115], v[92:95], v[28:31]
    s_add_u32 s35, s35, 10240
    s_cmp_eq_u32 s35, 151552
    v_mfma_f32_16x16x32_bf16 v[48:51], v[112:115], v[96:99], v[48:51]
    s_cselect_b32 s35, 49152, s35
    v_add_u32 v3, s34, v8
    v_mfma_f32_16x16x32_bf16 v[32:35], v[116:119], v[92:95], v[32:35]
    v_add_u32 v4, s35, v9
    v_mfma_f32_16x16x32_bf16 v[52:55], v[116:119], v[96:99], v[52:55]
    s_branch WO_loop
WO_last:
    s_cmp_eq_u32 s37, 1
    s_cbranch_scc1 WO_c3
    v_mfma_f32_16x16x32_bf16 v[24:27], v[108:111], v[92:95], v[24:27]
    v_mfma_f32_16x16x32_bf16 v[44:47], v[108:111], v[96:99], v[44:47]
    v_mfma_f32_16x16x32_bf16 v[28:31], v[112:115], v[92:95], v[28:31]
    v_mfma_f32_16x16x32_bf16 v[48:51], v[112:115], v[96:99], v[48:51]
    v_mfma_f32_16x16x32_bf16 v[32:35], v[116:119], v[92:95], v[32:35]
    v_mfma_f32_16x16x32_bf16 v[52:55], v[116:119], v[96:99], v[52:55]
    v_mfma_f32_16x16x32_bf16 v[16:19], v[100:103], v[92:95], v[16:19]
    v_mfma_f32_16x16x32_bf16 v[36:39], v[100:103], v[96:99], v[36:39]
    v_mfma_f32_16x16x32_bf16 v[20:23], v[104:107], v[92:95], v[20:23]
    v_mfma_f32_16x16x32_bf16 v[40:43], v[104:107], v[96:99], v[40:43]
    s_nop 3
    ds_write_b128 v7, v[24:27] offset:4096
    ds_write_b128 v7, v[44:47] offset:5120
    ds_write_b128 v7, v[28:31] offset:6144
    ds_write_b128 v7, v[48:51] offset:7168
    ds_write_b128 v7, v[32:35] offset:8192
    ds_write_b128 v7, v[52:55] offset:9216
    s_waitcnt lgkmcnt(0)
    s_barrier
    ds_read_b128 v[64:67], v7 offset:0
    ds_read_b128 v[68:71], v7 offset:1024
    ds_read_b128 v[72:75], v7 offset:2048
    ds_read_b128 v[76:79], v7 offset:3072
    s_waitcnt lgkmcnt(3)
    v_pk_add_f32 v[16:17], v[16:17], v[64:65]
    v_pk_add_f32 v[18:19], v[18:19], v[66:67]
    v_cvt_pk_bf16_f32 v92, v16, v17
    v_cvt_pk_bf16_f32 v93, v18, v19
    v_cvt_pk_bf16_f32 v232, v16, v17
    v_cvt_pk_bf16_f32 v233, v18, v19
    s_waitcnt lgkmcnt(2)
    v_pk_add_f32 v[36:37], v[36:37], v[68:69]
    v_pk_add_f32 v[38:39], v[38:39], v[70:71]
    v_cvt_pk_bf16_f32 v94, v36, v37
    v_cvt_pk_bf16_f32 v95, v38, v39
    v_cvt_pk_bf16_f32 v234, v36, v37
    v_cvt_pk_bf16_f32 v235, v38, v39
    v_permlane16_swap_b32 v92, v94
    v_permlane16_swap_b32 v93, v95
    buffer_store_dwordx4 v[92:95], v12, s[24:27], s46 offen sc1
    s_waitcnt lgkmcnt(1)
    v_pk_add_f32 v[20:21], v[20:21], v[72:73]
    v_pk_add_f32 v[22:23], v[22:23], v[74:75]
    v_cvt_pk_bf16_f32 v96, v20, v21
    v_cvt_pk_bf16_f32 v97, v22, v23
    v_cvt_pk_bf16_f32 v236, v20, v21
    v_cvt_pk_bf16_f32 v237, v22, v23
    s_waitcnt lgkmcnt(0)
    v_pk_add_f32 v[40:41], v[40:41], v[76:77]
    v_pk_add_f32 v[42:43], v[42:43], v[78:79]
    v_cvt_pk_bf16_f32 v98, v40, v41
    v_cvt_pk_bf16_f32 v99, v42, v43
    v_cvt_pk_bf16_f32 v238, v40, v41
    v_cvt_pk_bf16_f32 v239, v42, v43
    v_permlane16_swap_b32 v96, v98
    v_permlane16_swap_b32 v97, v99
    buffer_store_dwordx4 v[96:99], v12, s[24:27], s47 offen sc1
    v_dot2c_f32_bf16 v56, s40, v232
    v_dot2c_f32_bf16 v57, v232, v232
    v_dot2c_f32_bf16 v56, s40, v233
    v_dot2c_f32_bf16 v57, v233, v233
    v_dot2c_f32_bf16 v58, s40, v234
    v_dot2c_f32_bf16 v59, v234, v234
    v_dot2c_f32_bf16 v58, s40, v235
    v_dot2c_f32_bf16 v59, v235, v235
    v_dot2c_f32_bf16 v56, s40, v236
    v_dot2c_f32_bf16 v57, v236, v236
    v_dot2c_f32_bf16 v56, s40, v237
    v_dot2c_f32_bf16 v57, v237, v237
    v_dot2c_f32_bf16 v58, s40, v238
    v_dot2c_f32_bf16 v59, v238, v238
    v_dot2c_f32_bf16 v58, s40, v239
    v_dot2c_f32_bf16 v59, v239, v239
    s_branch WO_st
WO_c3:
    v_mfma_f32_16x16x32_bf16 v[16:19], v[100:103], v[92:95], v[16:19]
    v_mfma_f32_16x16x32_bf16 v[36:39], v[100:103], v[96:99], v[36:39]
    v_mfma_f32_16x16x32_bf16 v[20:23], v[104:107], v[92:95], v[20:23]
    v_mfma_f32_16x16x32_bf16 v[40:43], v[104:107], v[96:99], v[40:43]
    v_mfma_f32_16x16x32_bf16 v[24:27], v[108:111], v[92:95], v[24:27]
    v_mfma_f32_16x16x32_bf16 v[44:47], v[108:111], v[96:99], v[44:47]
    v_mfma_f32_16x16x32_bf16 v[28:31], v[112:115], v[92:95], v[28:31]
    v_mfma_f32_16x16x32_bf16 v[48:51], v[112:115], v[96:99], v[48:51]
    v_mfma_f32_16x16x32_bf16 v[32:35], v[116:119], v[92:95], v[32:35]
    v_mfma_f32_16x16x32_bf16 v[52:55], v[116:119], v[96:99], v[52:55]
    s_nop 3
    ds_write_b128 v7, v[16:19] offset:0
    ds_write_b128 v7, v[36:39] offset:1024
    ds_write_b128 v7, v[20:23] offset:2048
    ds_write_b128 v7, v[40:43] offset:3072
    s_waitcnt lgkmcnt(0)
    s_barrier
    ds_read_b128 v[64:67], v7 offset:4096
    ds_read_b128 v[68:71], v7 offset:5120
    ds_read_b128 v[72:75], v7 offset:6144
    ds_read_b128 v[76:79], v7 offset:7168
    ds_read_b128 v[80:83], v7 offset:8192
    ds_read_b128 v[84:87], v7 offset:9216
    s_waitcnt lgkmcnt(5)
    v_pk_add_f32 v[24:25], v[24:25], v[64:65]
    v_pk_add_f32 v[26:27], v[26:27], v[66:67]
    v_cvt_pk_bf16_f32 v92, v24, v25
    v_cvt_pk_bf16_f32 v93, v26, v27
    v_cvt_pk_bf16_f32 v232, v24, v25
    v_cvt_pk_bf16_f32 v233, v26, v27
    s_waitcnt lgkmcnt(4)
    v_pk_add_f32 v[44:45], v[44:45], v[68:69]
    v_pk_add_f32 v[46:47], v[46:47], v[70:71]
    v_cvt_pk_bf16_f32 v94, v44, v45
    v_cvt_pk_bf16_f32 v95, v46, v47
    v_cvt_pk_bf16_f32 v234, v44, v45
    v_cvt_pk_bf16_f32 v235, v46, v47
    v_permlane16_swap_b32 v92, v94
    v_permlane16_swap_b32 v93, v95
    buffer_store_dwordx4 v[92:95], v12, s[24:27], s46 offen sc1
    s_waitcnt lgkmcnt(3)
    v_pk_add_f32 v[28:29], v[28:29], v[72:73]
    v_pk_add_f32 v[30:31], v[30:31], v[74:75]
    v_cvt_pk_bf16_f32 v96, v28, v29
    v_cvt_pk_bf16_f32 v97, v30, v31
    v_cvt_pk_bf16_f32 v236, v28, v29
    v_cvt_pk_bf16_f32 v237, v30, v31
    s_waitcnt lgkmcnt(2)
    v_pk_add_f32 v[48:49], v[48:49], v[76:77]
    v_pk_add_f32 v[50:51], v[50:51], v[78:79]
    v_cvt_pk_bf16_f32 v98, v48, v49
    v_cvt_pk_bf16_f32 v99, v50, v51
    v_cvt_pk_bf16_f32 v238, v48, v49
    v_cvt_pk_bf16_f32 v239, v50, v51
    v_permlane16_swap_b32 v96, v98
    v_permlane16_swap_b32 v97, v99
    buffer_store_dwordx4 v[96:99], v12, s[24:27], s47 offen sc1
    s_waitcnt lgkmcnt(1)
    v_pk_add_f32 v[32:33], v[32:33], v[80:81]
    v_pk_add_f32 v[34:35], v[34:35], v[82:83]
    v_cvt_pk_bf16_f32 v100, v32, v33
    v_cvt_pk_bf16_f32 v101, v34, v35
    v_cvt_pk_bf16_f32 v240, v32, v33
    v_cvt_pk_bf16_f32 v241, v34, v35
    s_waitcnt lgkmcnt(0)
    v_pk_add_f32 v[52:53], v[52:53], v[84:85]
    v_pk_add_f32 v[54:55], v[54:55], v[86:87]
    v_cvt_pk_bf16_f32 v102, v52, v53
    v_cvt_pk_bf16_f32 v103, v54, v55
    v_cvt_pk_bf16_f32 v242, v52, v53
    v_cvt_pk_bf16_f32 v243, v54, v55
    v_permlane16_swap_b32 v100, v102
    v_permlane16_swap_b32 v101, v103
    buffer_store_dwordx4 v[100:103], v12, s[24:27], s48 offen sc1
    v_dot2c_f32_bf16 v56, s40, v232
    v_dot2c_f32_bf16 v57, v232, v232
    v_dot2c_f32_bf16 v56, s40, v233
    v_dot2c_f32_bf16 v57, v233, v233
    v_dot2c_f32_bf16 v58, s40, v234
    v_dot2c_f32_bf16 v59, v234, v234
    v_dot2c_f32_bf16 v58, s40, v235
    v_dot2c_f32_bf16 v59, v235, v235
    v_dot2c_f32_bf16 v56, s40, v236
    v_dot2c_f32_bf16 v57, v236, v236
    v_dot2c_f32_bf16 v56, s40, v237
    v_dot2c_f32_bf16 v57, v237, v237
    v_dot2c_f32_bf16 v58, s40, v238
    v_dot2c_f32_bf16 v59, v238, v238
    v_dot2c_f32_bf16 v58, s40, v239
    v_dot2c_f32_bf16 v59, v239, v239
    v_dot2c_f32_bf16 v56, s40, v240
    v_dot2c_f32_bf16 v57, v240, v240
    v_dot2c_f32_bf16 v56, s40, v241
    v_dot2c_f32_bf16 v57, v241, v241
    v_dot2c_f32_bf16 v58, s40, v242
    v_dot2c_f32_bf16 v59, v242, v242
    v_dot2c_f32_bf16 v58, s40, v243
    v_dot2c_f32_bf16 v59, v243, v243
WO_st:
    s_nop 2
    v_mov_b32 v60, v56
    v_mov_b32 v61, v57
    v_mov_b32 v62, v58
    v_mov_b32 v63, v59
    s_nop 0
    v_permlane16_swap_b32 v56, v60
    v_permlane16_swap_b32 v57, v61
    v_permlane16_swap_b32 v58, v62
    v_permlane16_swap_b32 v59, v63
    s_nop 0
    v_add_f32 v56, v56, v60
    v_add_f32 v57, v57, v61
    v_add_f32 v58, v58, v62
    v_add_f32 v59, v59, v63
    v_mov_b32 v60, v56
    v_mov_b32 v61, v57
    v_mov_b32 v62, v58
    v_mov_b32 v63, v59
    s_nop 0
    v_permlane32_swap_b32 v56, v60
    v_permlane32_swap_b32 v57, v61
    v_permlane32_swap_b32 v58, v62
    v_permlane32_swap_b32 v59, v63
    s_nop 0
    v_add_f32 v56, v56, v60
    v_add_f32 v57, v57, v61
    v_add_f32 v58, v58, v62
    v_add_f32 v59, v59, v63
    buffer_store_dwordx2 v[56:57], v11, s[24:27], s49 offen sc1
    buffer_store_dwordx2 v[58:59], v11, s[24:27], s49 offen offset:2048 sc1
WO_done:
    s_and_b32 s36, s28, 1
    s_lshr_b32 s37, s28, 1
    s_mul_i32 s10, s36, 10240
    v_add_u32 v3, s10, v2
    s_mul_i32 s10, s37, 3072
    s_add_u32 s10, s10, 4096
    v_add_u32 v4, s10, v2
    s_mov_b32 s34, 0
    s_mov_b32 s35, 0
    v_and_b32 v6, 15, v0
    v_lshrrev_b32 v7, 4, v0
    v_lshlrev_b32 v8, 4, v7
    s_mul_i32 s10, s37, 192
    s_add_u32 s10, s10, 122880
    v_add_u32 v9, s10, v8
    v_lshlrev_b32 v10, 4, v6
    s_lshl_b32 s10, s36, 10
    s_add_u32 s10, s10, 123904
    v_add_u32 v10, s10, v10
    s_movk_i32 s41, 512
    s_movk_i32 s40, 4096
    s_lshl_b32 s10, s54, 1
    s_add_u32 s10, s10, s36
    s_mul_i32 s10, s10, 196608
    s_mul_i32 s11, s55, 12288
    s_add_u32 s10, s10, s11
    s_add_u32 s10, s10, 13631488
    s_cmp_eq_u32 s37, 1
    s_cselect_b32 s44, 4608, 0
    s_cselect_b32 s45, 8192, s41
    s_cselect_b32 s46, 8704, s40
    s_add_u32 s44, s44, s10
    s_add_u32 s45, s45, s10
    s_add_u32 s46, s46, s10
    s_mov_b32 s41, 40960
    v_mov_b32 v16, 0
    v_mov_b32 v17, 0
    v_mov_b32 v18, 0
    v_mov_b32 v19, 0
    v_mov_b32 v20, 0
    v_mov_b32 v21, 0
    v_mov_b32 v22, 0
    v_mov_b32 v23, 0
    v_mov_b32 v24, 0
    v_mov_b32 v25, 0
    v_mov_b32 v26, 0
    v_mov_b32 v27, 0
    v_mov_b32 v28, 0
    v_mov_b32 v29, 0
    v_mov_b32 v30, 0
    v_mov_b32 v31, 0
    v_mov_b32 v32, 0
    v_mov_b32 v33, 0
    v_mov_b32 v34, 0
    v_mov_b32 v35, 0
    v_mov_b32 v36, 0
    v_mov_b32 v37, 0
    v_mov_b32 v38, 0
    v_mov_b32 v39, 0
    v_mov_b32 v40, 0
    v_mov_b32 v41, 0
    v_mov_b32 v42, 0
    v_mov_b32 v43, 0
    v_mov_b32 v44, 0
    v_mov_b32 v45, 0
    v_mov_b32 v46, 0
    v_mov_b32 v47, 0
    v_mov_b32 v48, 0
    v_mov_b32 v49, 0
    v_mov_b32 v50, 0
    v_mov_b32 v51, 0
    v_mov_b32 v52, 0
    v_mov_b32 v53, 0
    v_mov_b32 v54, 0
    v_mov_b32 v55, 0
    v_mov_b32 v56, 0
    v_mov_b32 v57, 0
    v_mov_b32 v58, 0
    v_mov_b32 v59, 0
    v_mov_b32 v60, 0
    v_mov_b32 v61, 0
    v_mov_b32 v62, 0
    v_mov_b32 v63, 0
    v_mov_b32 v64, 0
    v_mov_b32 v65, 0
    v_mov_b32 v66, 0
    v_mov_b32 v67, 0
    v_mov_b32 v68, 0
    v_mov_b32 v69, 0
    v_mov_b32 v70, 0
    v_mov_b32 v71, 0
    v_mov_b32 v72, 0
    v_mov_b32 v73, 0
    v_mov_b32 v74, 0
    v_mov_b32 v75, 0
    v_mov_b32 v76, 0
    v_mov_b32 v77, 0
    v_mov_b32 v78, 0
    v_mov_b32 v79, 0
    v_mov_b32 v80, 0
    v_mov_b32 v81, 0
    v_mov_b32 v82, 0
    v_mov_b32 v83, 0
    v_mov_b32 v84, 0
    v_mov_b32 v85, 0
    v_mov_b32 v86, 0
    v_mov_b32 v87, 0
    v_mov_b32 v88, 0
    v_mov_b32 v89, 0
    v_mov_b32 v90, 0
    v_mov_b32 v91, 0
    v_mov_b32 v92, 0
    v_mov_b32 v93, 0
    v_mov_b32 v94, 0
    v_mov_b32 v95, 0
    v_mov_b32 v96, 0
    v_mov_b32 v97, 0
    v_mov_b32 v98, 0
    v_mov_b32 v99, 0
    v_mov_b32 v100, 0
    v_mov_b32 v101, 0
    v_mov_b32 v102, 0
    v_mov_b32 v103, 0
    v_mov_b32 v104, 0
    v_mov_b32 v105, 0
    v_mov_b32 v106, 0
    v_mov_b32 v107, 0
    v_mov_b32 v108, 0
    v_mov_b32 v109, 0
    v_mov_b32 v110, 0
    v_mov_b32 v111, 0
    s_waitcnt vmcnt(0)
    s_barrier
    s_barrier
    s_barrier
    ds_read_b128 v[112:115], v3 offset:0
    ds_read_b128 v[128:131], v4 offset:0
    ds_read_b128 v[116:119], v3 offset:1024
    ds_read_b128 v[120:123], v3 offset:2048
    ds_read_b128 v[124:127], v3 offset:3072
    ds_read_b128 v[132:135], v4 offset:1024
    ds_read_b128 v[136:139], v4 offset:2048
    ds_read_b128 v[140:143], v4 offset:10240
    ds_read_b128 v[144:147], v4 offset:11264
    ds_read_b128 v[148:151], v4 offset:12288
GU_loop:
    s_waitcnt lgkmcnt(8)
    v_mfma_f32_16x16x32_bf16 v[16:19], v[128:131], v[112:115], v[16:19]
    ds_read_b128 v[152:155], v3 offset:20480
    s_waitcnt lgkmcnt(8)
    v_mfma_f32_16x16x32_bf16 v[40:43], v[128:131], v[116:119], v[40:43]
    s_waitcnt lgkmcnt(7)
    v_mfma_f32_16x16x32_bf16 v[64:67], v[128:131], v[120:123], v[64:67]
    ds_read_b128 v[168:171], v4 offset:20480
    s_waitcnt lgkmcnt(7)
    v_mfma_f32_16x16x32_bf16 v[88:91], v[128:131], v[124:127], v[88:91]
    s_waitcnt lgkmcnt(6)
    v_mfma_f32_16x16x32_bf16 v[20:23], v[132:135], v[112:115], v[20:23]
    ds_read_b128 v[156:159], v3 offset:21504
    v_mfma_f32_16x16x32_bf16 v[44:47], v[132:135], v[116:119], v[44:47]
    v_mfma_f32_16x16x32_bf16 v[68:71], v[132:135], v[120:123], v[68:71]
    ds_read_b128 v[160:163], v3 offset:22528
    v_mfma_f32_16x16x32_bf16 v[92:95], v[132:135], v[124:127], v[92:95]
    s_waitcnt lgkmcnt(7)
    v_mfma_f32_16x16x32_bf16 v[24:27], v[136:139], v[112:115], v[24:27]
    ds_read_b128 v[164:167], v3 offset:23552
    v_mfma_f32_16x16x32_bf16 v[48:51], v[136:139], v[116:119], v[48:51]
    v_mfma_f32_16x16x32_bf16 v[72:75], v[136:139], v[120:123], v[72:75]
    ds_read_b128 v[172:175], v4 offset:21504
    v_mfma_f32_16x16x32_bf16 v[96:99], v[136:139], v[124:127], v[96:99]
    s_waitcnt lgkmcnt(8)
    v_mfma_f32_16x16x32_bf16 v[28:31], v[140:143], v[112:115], v[28:31]
    ds_read_b128 v[176:179], v4 offset:22528
    v_mfma_f32_16x16x32_bf16 v[52:55], v[140:143], v[116:119], v[52:55]
    v_mfma_f32_16x16x32_bf16 v[76:79], v[140:143], v[120:123], v[76:79]
    ds_read_b128 v[180:183], v4 offset:30720
    v_mfma_f32_16x16x32_bf16 v[100:103], v[140:143], v[124:127], v[100:103]
    s_waitcnt lgkmcnt(9)
    v_mfma_f32_16x16x32_bf16 v[32:35], v[144:147], v[112:115], v[32:35]
    ds_read_b128 v[184:187], v4 offset:31744
    v_mfma_f32_16x16x32_bf16 v[56:59], v[144:147], v[116:119], v[56:59]
    s_add_u32 s35, s35, 1
    v_mfma_f32_16x16x32_bf16 v[80:83], v[144:147], v[120:123], v[80:83]
    ds_read_b128 v[188:191], v4 offset:32768
    v_mfma_f32_16x16x32_bf16 v[104:107], v[144:147], v[124:127], v[104:107]
    s_add_u32 s34, s34, 1
    s_waitcnt lgkmcnt(10)
    v_mfma_f32_16x16x32_bf16 v[36:39], v[148:151], v[112:115], v[36:39]
    v_mfma_f32_16x16x32_bf16 v[60:63], v[148:151], v[116:119], v[60:63]
    s_cmp_eq_u32 s35, 3
    v_mfma_f32_16x16x32_bf16 v[84:87], v[148:151], v[120:123], v[84:87]
    s_cselect_b32 s40, 4294885376, s41
    v_mfma_f32_16x16x32_bf16 v[108:111], v[148:151], v[124:127], v[108:111]
    s_cselect_b32 s35, 0, s35
    v_add_u32 v3, s40, v3
    v_add_u32 v4, s40, v4
    s_cmp_eq_u32 s34, 10
    s_waitcnt lgkmcnt(0)
    v_mfma_f32_16x16x32_bf16 v[16:19], v[168:171], v[152:155], v[16:19]
    s_cbranch_scc1 GU_last
    s_barrier
    v_mfma_f32_16x16x32_bf16 v[40:43], v[168:171], v[156:159], v[40:43]
    ds_read_b128 v[112:115], v3 offset:0
    v_mfma_f32_16x16x32_bf16 v[64:67], v[168:171], v[160:163], v[64:67]
    v_mfma_f32_16x16x32_bf16 v[88:91], v[168:171], v[164:167], v[88:91]
    ds_read_b128 v[128:131], v4 offset:0
    v_mfma_f32_16x16x32_bf16 v[20:23], v[172:175], v[152:155], v[20:23]
    v_mfma_f32_16x16x32_bf16 v[44:47], v[172:175], v[156:159], v[44:47]
    ds_read_b128 v[116:119], v3 offset:1024
    v_mfma_f32_16x16x32_bf16 v[68:71], v[172:175], v[160:163], v[68:71]
    v_mfma_f32_16x16x32_bf16 v[92:95], v[172:175], v[164:167], v[92:95]
    ds_read_b128 v[120:123], v3 offset:2048
    v_mfma_f32_16x16x32_bf16 v[24:27], v[176:179], v[152:155], v[24:27]
    v_mfma_f32_16x16x32_bf16 v[48:51], v[176:179], v[156:159], v[48:51]
    ds_read_b128 v[124:127], v3 offset:3072
    v_mfma_f32_16x16x32_bf16 v[72:75], v[176:179], v[160:163], v[72:75]
    v_mfma_f32_16x16x32_bf16 v[96:99], v[176:179], v[164:167], v[96:99]
    ds_read_b128 v[132:135], v4 offset:1024
    v_mfma_f32_16x16x32_bf16 v[28:31], v[180:183], v[152:155], v[28:31]
    v_mfma_f32_16x16x32_bf16 v[52:55], v[180:183], v[156:159], v[52:55]
    ds_read_b128 v[136:139], v4 offset:2048
    v_mfma_f32_16x16x32_bf16 v[76:79], v[180:183], v[160:163], v[76:79]
    v_mfma_f32_16x16x32_bf16 v[100:103], v[180:183], v[164:167], v[100:103]
    ds_read_b128 v[140:143], v4 offset:10240
    v_mfma_f32_16x16x32_bf16 v[32:35], v[184:187], v[152:155], v[32:35]
    v_mfma_f32_16x16x32_bf16 v[56:59], v[184:187], v[156:159], v[56:59]
    ds_read_b128 v[144:147], v4 offset:11264
    v_mfma_f32_16x16x32_bf16 v[80:83], v[184:187], v[160:163], v[80:83]
    v_mfma_f32_16x16x32_bf16 v[104:107], v[184:187], v[164:167], v[104:107]
    ds_read_b128 v[148:151], v4 offset:12288
    v_mfma_f32_16x16x32_bf16 v[36:39], v[188:191], v[152:155], v[36:39]
    v_mfma_f32_16x16x32_bf16 v[60:63], v[188:191], v[156:159], v[60:63]
    v_mfma_f32_16x16x32_bf16 v[84:87], v[188:191], v[160:163], v[84:87]
    v_mfma_f32_16x16x32_bf16 v[108:111], v[188:191], v[164:167], v[108:111]
    s_branch GU_loop
GU_last:
    s_barrier
    v_mfma_f32_16x16x32_bf16 v[20:23], v[172:175], v[152:155], v[20:23]
    ds_read_b128 v[216:219], v10
    ds_read_b128 v[192:195], v9 offset:0
    v_mfma_f32_16x16x32_bf16 v[24:27], v[176:179], v[152:155], v[24:27]
    ds_read_b128 v[196:199], v9 offset:64
    ds_read_b128 v[200:203], v9 offset:128
    v_mfma_f32_16x16x32_bf16 v[28:31], v[180:183], v[152:155], v[28:31]
    ds_read_b128 v[204:207], v9 offset:384
    ds_read_b128 v[208:211], v9 offset:448
    v_mfma_f32_16x16x32_bf16 v[32:35], v[184:187], v[152:155], v[32:35]
    ds_read_b128 v[212:215], v9 offset:512
    ds_read_b128 v[220:223], v10 offset:256
    v_mfma_f32_16x16x32_bf16 v[36:39], v[188:191], v[152:155], v[36:39]
    ds_read_b128 v[224:227], v10 offset:512
    ds_read_b128 v[228:231], v10 offset:768
    v_mfma_f32_16x16x32_bf16 v[40:43], v[168:171], v[156:159], v[40:43]
    v_mfma_f32_16x16x32_bf16 v[44:47], v[172:175], v[156:159], v[44:47]
    v_mfma_f32_16x16x32_bf16 v[48:51], v[176:179], v[156:159], v[48:51]
    v_mfma_f32_16x16x32_bf16 v[52:55], v[180:183], v[156:159], v[52:55]
    v_mfma_f32_16x16x32_bf16 v[56:59], v[184:187], v[156:159], v[56:59]
    v_mfma_f32_16x16x32_bf16 v[60:63], v[188:191], v[156:159], v[60:63]
    s_waitcnt lgkmcnt(0)
    v_mfma_f32_16x16x32_bf16 v[64:67], v[168:171], v[160:163], v[64:67]
    v_fmac_f32 v16, v192, v216
    v_fmac_f32 v17, v193, v216
    v_mfma_f32_16x16x32_bf16 v[68:71], v[172:175], v[160:163], v[68:71]
    v_fmac_f32 v18, v194, v216
    v_fmac_f32 v19, v195, v216
    v_mfma_f32_16x16x32_bf16 v[72:75], v[176:179], v[160:163], v[72:75]
    v_fmac_f32 v20, v196, v216
    v_fmac_f32 v21, v197, v216
    v_mfma_f32_16x16x32_bf16 v[76:79], v[180:183], v[160:163], v[76:79]
    v_fmac_f32 v22, v198, v216
    v_fmac_f32 v23, v199, v216
    v_mfma_f32_16x16x32_bf16 v[80:83], v[184:187], v[160:163], v[80:83]
    v_fmac_f32 v24, v200, v216
    v_fmac_f32 v25, v201, v216
    v_mfma_f32_16x16x32_bf16 v[84:87], v[188:191], v[160:163], v[84:87]
    v_fmac_f32 v26, v202, v216
    v_fmac_f32 v27, v203, v216
    v_mfma_f32_16x16x32_bf16 v[88:91], v[168:171], v[164:167], v[88:91]
    v_fmac_f32 v28, v204, v216
    v_fmac_f32 v29, v205, v216
    v_mfma_f32_16x16x32_bf16 v[92:95], v[172:175], v[164:167], v[92:95]
    v_fmac_f32 v30, v206, v216
    v_fmac_f32 v31, v207, v216
    v_mfma_f32_16x16x32_bf16 v[96:99], v[176:179], v[164:167], v[96:99]
    v_fmac_f32 v32, v208, v216
    v_fmac_f32 v33, v209, v216
    v_mfma_f32_16x16x32_bf16 v[100:103], v[180:183], v[164:167], v[100:103]
    v_fmac_f32 v34, v210, v216
    v_fmac_f32 v35, v211, v216
    v_mfma_f32_16x16x32_bf16 v[104:107], v[184:187], v[164:167], v[104:107]
    v_fmac_f32 v36, v212, v216
    v_fmac_f32 v37, v213, v216
    v_mfma_f32_16x16x32_bf16 v[108:111], v[188:191], v[164:167], v[108:111]
    v_fmac_f32 v38, v214, v216
    v_fmac_f32 v39, v215, v216
    v_pk_mul_f32 v[152:153], v[16:17], v[16:17]
    v_pk_mul_f32 v[154:155], v[18:19], v[18:19]
    v_pk_mul_f32 v[156:157], v[20:21], v[20:21]
    v_pk_mul_f32 v[158:159], v[22:23], v[22:23]
    v_pk_mul_f32 v[160:161], v[24:25], v[24:25]
    v_pk_mul_f32 v[162:163], v[26:27], v[26:27]
    v_pk_fma_f32 v[152:153], v[152:153], v[218:219], v[218:219] op_sel:[0,1,0] op_sel_hi:[1,1,0]
    v_pk_fma_f32 v[154:155], v[154:155], v[218:219], v[218:219] op_sel:[0,1,0] op_sel_hi:[1,1,0]
    v_pk_fma_f32 v[156:157], v[156:157], v[218:219], v[218:219] op_sel:[0,1,0] op_sel_hi:[1,1,0]
    v_pk_fma_f32 v[158:159], v[158:159], v[218:219], v[218:219] op_sel:[0,1,0] op_sel_hi:[1,1,0]
    v_pk_fma_f32 v[160:161], v[160:161], v[218:219], v[218:219] op_sel:[0,1,0] op_sel_hi:[1,1,0]
    v_pk_fma_f32 v[162:163], v[162:163], v[218:219], v[218:219] op_sel:[0,1,0] op_sel_hi:[1,1,0]
    v_pk_mul_f32 v[152:153], v[152:153], v[16:17]
    v_pk_mul_f32 v[154:155], v[154:155], v[18:19]
    v_pk_mul_f32 v[156:157], v[156:157], v[20:21]
    v_pk_mul_f32 v[158:159], v[158:159], v[22:23]
    v_pk_mul_f32 v[160:161], v[160:161], v[24:25]
    v_pk_mul_f32 v[162:163], v[162:163], v[26:27]
    v_pk_mul_f32 v[16:17], v[16:17], v[28:29]
    v_pk_mul_f32 v[18:19], v[18:19], v[30:31]
    v_pk_mul_f32 v[20:21], v[20:21], v[32:33]
    v_pk_mul_f32 v[22:23], v[22:23], v[34:35]
    v_pk_mul_f32 v[24:25], v[24:25], v[36:37]
    v_pk_mul_f32 v[26:27], v[26:27], v[38:39]
    v_exp_f32 v152, v152
    v_pk_fma_f32 v[40:41], v[192:193], v[220:221], v[40:41] op_sel_hi:[1,0,1]
    v_exp_f32 v153, v153
    v_pk_fma_f32 v[42:43], v[194:195], v[220:221], v[42:43] op_sel_hi:[1,0,1]
    v_pk_fma_f32 v[44:45], v[196:197], v[220:221], v[44:45] op_sel_hi:[1,0,1]
    v_exp_f32 v154, v154
    v_pk_fma_f32 v[46:47], v[198:199], v[220:221], v[46:47] op_sel_hi:[1,0,1]
    v_exp_f32 v155, v155
    v_pk_fma_f32 v[48:49], v[200:201], v[220:221], v[48:49] op_sel_hi:[1,0,1]
    v_pk_fma_f32 v[50:51], v[202:203], v[220:221], v[50:51] op_sel_hi:[1,0,1]
    v_pk_fma_f32 v[152:153], v[152:153], v[216:217], v[216:217] op_sel:[0,1,1] op_sel_hi:[1,1,1]
    v_exp_f32 v156, v156
    v_pk_fma_f32 v[52:53], v[204:205], v[220:221], v[52:53] op_sel_hi:[1,0,1]
    v_exp_f32 v157, v157
    v_pk_fma_f32 v[54:55], v[206:207], v[220:221], v[54:55] op_sel_hi:[1,0,1]
    v_pk_fma_f32 v[56:57], v[208:209], v[220:221], v[56:57] op_sel_hi:[1,0,1]
    v_pk_fma_f32 v[154:155], v[154:155], v[216:217], v[216:217] op_sel:[0,1,1] op_sel_hi:[1,1,1]
    v_exp_f32 v158, v158
    v_pk_fma_f32 v[58:59], v[210:211], v[220:221], v[58:59] op_sel_hi:[1,0,1]
    v_exp_f32 v159, v159
    v_pk_fma_f32 v[60:61], v[212:213], v[220:221], v[60:61] op_sel_hi:[1,0,1]
    v_pk_fma_f32 v[62:63], v[214:215], v[220:221], v[62:63] op_sel_hi:[1,0,1]
    v_pk_fma_f32 v[156:157], v[156:157], v[216:217], v[216:217] op_sel:[0,1,1] op_sel_hi:[1,1,1]
    v_exp_f32 v160, v160
    v_pk_mul_f32 v[164:165], v[40:41], v[40:41]
    v_exp_f32 v161, v161
    v_pk_mul_f32 v[166:167], v[42:43], v[42:43]
    v_pk_mul_f32 v[168:169], v[44:45], v[44:45]
    v_pk_fma_f32 v[158:159], v[158:159], v[216:217], v[216:217] op_sel:[0,1,1] op_sel_hi:[1,1,1]
    v_exp_f32 v162, v162
    v_pk_mul_f32 v[170:171], v[46:47], v[46:47]
    v_exp_f32 v163, v163
    v_pk_mul_f32 v[172:173], v[48:49], v[48:49]
    v_pk_mul_f32 v[174:175], v[50:51], v[50:51]
    v_pk_fma_f32 v[160:161], v[160:161], v[216:217], v[216:217] op_sel:[0,1,1] op_sel_hi:[1,1,1]
    v_rcp_f32 v152, v152
    v_pk_fma_f32 v[164:165], v[164:165], v[222:223], v[222:223] op_sel:[0,1,0] op_sel_hi:[1,1,0]
    v_pk_fma_f32 v[162:163], v[162:163], v[216:217], v[216:217] op_sel:[0,1,1] op_sel_hi:[1,1,1]
    v_rcp_f32 v153, v153
    v_pk_fma_f32 v[166:167], v[166:167], v[222:223], v[222:223] op_sel:[0,1,0] op_sel_hi:[1,1,0]
    v_pk_fma_f32 v[168:169], v[168:169], v[222:223], v[222:223] op_sel:[0,1,0] op_sel_hi:[1,1,0]
    v_rcp_f32 v154, v154
    v_pk_fma_f32 v[170:171], v[170:171], v[222:223], v[222:223] op_sel:[0,1,0] op_sel_hi:[1,1,0]
    v_rcp_f32 v155, v155
    v_pk_fma_f32 v[172:173], v[172:173], v[222:223], v[222:223] op_sel:[0,1,0] op_sel_hi:[1,1,0]
    v_pk_fma_f32 v[174:175], v[174:175], v[222:223], v[222:223] op_sel:[0,1,0] op_sel_hi:[1,1,0]
    v_pk_mul_f32 v[16:17], v[16:17], v[152:153]
    v_rcp_f32 v156, v156
    v_pk_mul_f32 v[164:165], v[164:165], v[40:41]
    v_rcp_f32 v157, v157
    v_pk_mul_f32 v[166:167], v[166:167], v[42:43]
    v_pk_mul_f32 v[168:169], v[168:169], v[44:45]
    v_pk_mul_f32 v[18:19], v[18:19], v[154:155]
    v_rcp_f32 v158, v158
    v_pk_mul_f32 v[170:171], v[170:171], v[46:47]
    v_cvt_pk_bf16_f32 v112, v16, v17
    v_rcp_f32 v159, v159
    v_pk_mul_f32 v[172:173], v[172:173], v[48:49]
    v_pk_mul_f32 v[174:175], v[174:175], v[50:51]
    v_pk_mul_f32 v[20:21], v[20:21], v[156:157]
    v_rcp_f32 v160, v160
    v_pk_mul_f32 v[40:41], v[40:41], v[52:53]
    v_cvt_pk_bf16_f32 v113, v18, v19
    v_rcp_f32 v161, v161
    v_pk_mul_f32 v[42:43], v[42:43], v[54:55]
    v_pk_mul_f32 v[44:45], v[44:45], v[56:57]
    v_pk_mul_f32 v[22:23], v[22:23], v[158:159]
    v_rcp_f32 v162, v162
    v_pk_mul_f32 v[46:47], v[46:47], v[58:59]
    v_cvt_pk_bf16_f32 v116, v20, v21
    v_rcp_f32 v163, v163
    v_pk_mul_f32 v[48:49], v[48:49], v[60:61]
    v_pk_mul_f32 v[50:51], v[50:51], v[62:63]
    v_pk_mul_f32 v[24:25], v[24:25], v[160:161]
    v_cvt_pk_bf16_f32 v117, v22, v23
    v_pk_mul_f32 v[26:27], v[26:27], v[162:163]
    v_cvt_pk_bf16_f32 v120, v24, v25
    s_nop 0
    v_cvt_pk_bf16_f32 v121, v26, v27
    v_exp_f32 v164, v164
    v_pk_fma_f32 v[64:65], v[192:193], v[224:225], v[64:65] op_sel_hi:[1,0,1]
    v_exp_f32 v165, v165
    v_pk_fma_f32 v[66:67], v[194:195], v[224:225], v[66:67] op_sel_hi:[1,0,1]
    v_pk_fma_f32 v[68:69], v[196:197], v[224:225], v[68:69] op_sel_hi:[1,0,1]
    v_exp_f32 v166, v166
    v_pk_fma_f32 v[70:71], v[198:199], v[224:225], v[70:71] op_sel_hi:[1,0,1]
    v_exp_f32 v167, v167
    v_pk_fma_f32 v[72:73], v[200:201], v[224:225], v[72:73] op_sel_hi:[1,0,1]
    v_pk_fma_f32 v[74:75], v[202:203], v[224:225], v[74:75] op_sel_hi:[1,0,1]
    v_pk_fma_f32 v[164:165], v[164:165], v[220:221], v[220:221] op_sel:[0,1,1] op_sel_hi:[1,1,1]
    v_exp_f32 v168, v168
    v_pk_fma_f32 v[76:77], v[204:205], v[224:225], v[76:77] op_sel_hi:[1,0,1]
    v_exp_f32 v169, v169
    v_pk_fma_f32 v[78:79], v[206:207], v[224:225], v[78:79] op_sel_hi:[1,0,1]
    v_pk_fma_f32 v[80:81], v[208:209], v[224:225], v[80:81] op_sel_hi:[1,0,1]
    v_pk_fma_f32 v[166:167], v[166:167], v[220:221], v[220:221] op_sel:[0,1,1] op_sel_hi:[1,1,1]
    v_exp_f32 v170, v170
    v_pk_fma_f32 v[82:83], v[210:211], v[224:225], v[82:83] op_sel_hi:[1,0,1]
    v_exp_f32 v171, v171
    v_pk_fma_f32 v[84:85], v[212:213], v[224:225], v[84:85] op_sel_hi:[1,0,1]
    v_pk_fma_f32 v[86:87], v[214:215], v[224:225], v[86:87] op_sel_hi:[1,0,1]
    v_pk_fma_f32 v[168:169], v[168:169], v[220:221], v[220:221] op_sel:[0,1,1] op_sel_hi:[1,1,1]
    v_exp_f32 v172, v172
    v_pk_mul_f32 v[152:153], v[64:65], v[64:65]
    v_exp_f32 v173, v173
    v_pk_mul_f32 v[154:155], v[66:67], v[66:67]
    v_pk_mul_f32 v[156:157], v[68:69], v[68:69]
    v_pk_fma_f32 v[170:171], v[170:171], v[220:221], v[220:221] op_sel:[0,1,1] op_sel_hi:[1,1,1]
    v_exp_f32 v174, v174
    v_pk_mul_f32 v[158:159], v[70:71], v[70:71]
    v_exp_f32 v175, v175
    v_pk_mul_f32 v[160:161], v[72:73], v[72:73]
    v_pk_mul_f32 v[162:163], v[74:75], v[74:75]
    v_pk_fma_f32 v[172:173], v[172:173], v[220:221], v[220:221] op_sel:[0,1,1] op_sel_hi:[1,1,1]
    v_rcp_f32 v164, v164
    v_pk_fma_f32 v[152:153], v[152:153], v[226:227], v[226:227] op_sel:[0,1,0] op_sel_hi:[1,1,0]
    v_pk_fma_f32 v[174:175], v[174:175], v[220:221], v[220:221] op_sel:[0,1,1] op_sel_hi:[1,1,1]
    v_rcp_f32 v165, v165
    v_pk_fma_f32 v[154:155], v[154:155], v[226:227], v[226:227] op_sel:[0,1,0] op_sel_hi:[1,1,0]
    v_pk_fma_f32 v[156:157], v[156:157], v[226:227], v[226:227] op_sel:[0,1,0] op_sel_hi:[1,1,0]
    v_rcp_f32 v166, v166
    v_pk_fma_f32 v[158:159], v[158:159], v[226:227], v[226:227] op_sel:[0,1,0] op_sel_hi:[1,1,0]
    v_rcp_f32 v167, v167
    v_pk_fma_f32 v[160:161], v[160:161], v[226:227], v[226:227] op_sel:[0,1,0] op_sel_hi:[1,1,0]
    v_pk_fma_f32 v[162:163], v[162:163], v[226:227], v[226:227] op_sel:[0,1,0] op_sel_hi:[1,1,0]
    v_pk_mul_f32 v[40:41], v[40:41], v[164:165]
    v_rcp_f32 v168, v168
    v_pk_mul_f32 v[152:153], v[152:153], v[64:65]
    v_rcp_f32 v169, v169
    v_pk_mul_f32 v[154:155], v[154:155], v[66:67]
    v_pk_mul_f32 v[156:157], v[156:157], v[68:69]
    v_pk_mul_f32 v[42:43], v[42:43], v[166:167]
    v_rcp_f32 v170, v170
    v_pk_mul_f32 v[158:159], v[158:159], v[70:71]
    v_cvt_pk_bf16_f32 v114, v40, v41
    v_rcp_f32 v171, v171
    v_pk_mul_f32 v[160:161], v[160:161], v[72:73]
    v_pk_mul_f32 v[162:163], v[162:163], v[74:75]
    v_pk_mul_f32 v[44:45], v[44:45], v[168:169]
    v_rcp_f32 v172, v172
    v_pk_mul_f32 v[64:65], v[64:65], v[76:77]
    v_cvt_pk_bf16_f32 v115, v42, v43
    v_rcp_f32 v173, v173
    v_pk_mul_f32 v[66:67], v[66:67], v[78:79]
    v_pk_mul_f32 v[68:69], v[68:69], v[80:81]
    v_pk_mul_f32 v[46:47], v[46:47], v[170:171]
    v_rcp_f32 v174, v174
    v_pk_mul_f32 v[70:71], v[70:71], v[82:83]
    v_cvt_pk_bf16_f32 v118, v44, v45
    v_rcp_f32 v175, v175
    v_pk_mul_f32 v[72:73], v[72:73], v[84:85]
    v_pk_mul_f32 v[74:75], v[74:75], v[86:87]
    v_pk_mul_f32 v[48:49], v[48:49], v[172:173]
    v_cvt_pk_bf16_f32 v119, v46, v47
    v_pk_mul_f32 v[50:51], v[50:51], v[174:175]
    v_cvt_pk_bf16_f32 v122, v48, v49
    s_nop 0
    v_cvt_pk_bf16_f32 v123, v50, v51
    v_permlane16_swap_b32 v112, v114
    v_permlane16_swap_b32 v113, v115
    v_permlane16_swap_b32 v116, v118
    v_permlane16_swap_b32 v117, v119
    v_permlane16_swap_b32 v120, v122
    v_permlane16_swap_b32 v121, v123
    buffer_store_dwordx4 v[112:115], v12, s[24:27], s44 offen offset:0 sc1
    buffer_store_dwordx4 v[116:119], v12, s[24:27], s45 offen offset:0 sc1
    buffer_store_dwordx4 v[120:123], v12, s[24:27], s46 offen offset:0 sc1
    v_exp_f32 v152, v152
    v_pk_fma_f32 v[88:89], v[192:193], v[228:229], v[88:89] op_sel_hi:[1,0,1]
    v_exp_f32 v153, v153
    v_pk_fma_f32 v[90:91], v[194:195], v[228:229], v[90:91] op_sel_hi:[1,0,1]
    v_pk_fma_f32 v[92:93], v[196:197], v[228:229], v[92:93] op_sel_hi:[1,0,1]
    v_exp_f32 v154, v154
    v_pk_fma_f32 v[94:95], v[198:199], v[228:229], v[94:95] op_sel_hi:[1,0,1]
    v_exp_f32 v155, v155
    v_pk_fma_f32 v[96:97], v[200:201], v[228:229], v[96:97] op_sel_hi:[1,0,1]
    v_pk_fma_f32 v[98:99], v[202:203], v[228:229], v[98:99] op_sel_hi:[1,0,1]
    v_pk_fma_f32 v[152:153], v[152:153], v[224:225], v[224:225] op_sel:[0,1,1] op_sel_hi:[1,1,1]
    v_exp_f32 v156, v156
    v_pk_fma_f32 v[100:101], v[204:205], v[228:229], v[100:101] op_sel_hi:[1,0,1]
    v_exp_f32 v157, v157
    v_pk_fma_f32 v[102:103], v[206:207], v[228:229], v[102:103] op_sel_hi:[1,0,1]
    v_pk_fma_f32 v[104:105], v[208:209], v[228:229], v[104:105] op_sel_hi:[1,0,1]
    v_pk_fma_f32 v[154:155], v[154:155], v[224:225], v[224:225] op_sel:[0,1,1] op_sel_hi:[1,1,1]
    v_exp_f32 v158, v158
    v_pk_fma_f32 v[106:107], v[210:211], v[228:229], v[106:107] op_sel_hi:[1,0,1]
    v_exp_f32 v159, v159
    v_pk_fma_f32 v[108:109], v[212:213], v[228:229], v[108:109] op_sel_hi:[1,0,1]
    v_pk_fma_f32 v[110:111], v[214:215], v[228:229], v[110:111] op_sel_hi:[1,0,1]
    v_pk_fma_f32 v[156:157], v[156:157], v[224:225], v[224:225] op_sel:[0,1,1] op_sel_hi:[1,1,1]
    v_exp_f32 v160, v160
    v_pk_mul_f32 v[164:165], v[88:89], v[88:89]
    v_exp_f32 v161, v161
    v_pk_mul_f32 v[166:167], v[90:91], v[90:91]
    v_pk_mul_f32 v[168:169], v[92:93], v[92:93]
    v_pk_fma_f32 v[158:159], v[158:159], v[224:225], v[224:225] op_sel:[0,1,1] op_sel_hi:[1,1,1]
    v_exp_f32 v162, v162
    v_pk_mul_f32 v[170:171], v[94:95], v[94:95]
    v_exp_f32 v163, v163
    v_pk_mul_f32 v[172:173], v[96:97], v[96:97]
    v_pk_mul_f32 v[174:175], v[98:99], v[98:99]
    v_pk_fma_f32 v[160:161], v[160:161], v[224:225], v[224:225] op_sel:[0,1,1] op_sel_hi:[1,1,1]
    v_rcp_f32 v152, v152
    v_pk_fma_f32 v[164:165], v[164:165], v[230:231], v[230:231] op_sel:[0,1,0] op_sel_hi:[1,1,0]
    v_pk_fma_f32 v[162:163], v[162:163], v[224:225], v[224:225] op_sel:[0,1,1] op_sel_hi:[1,1,1]
    v_rcp_f32 v153, v153
    v_pk_fma_f32 v[166:167], v[166:167], v[230:231], v[230:231] op_sel:[0,1,0] op_sel_hi:[1,1,0]
    v_pk_fma_f32 v[168:169], v[168:169], v[230:231], v[230:231] op_sel:[0,1,0] op_sel_hi:[1,1,0]
    v_rcp_f32 v154, v154
    v_pk_fma_f32 v[170:171], v[170:171], v[230:231], v[230:231] op_sel:[0,1,0] op_sel_hi:[1,1,0]
    v_rcp_f32 v155, v155
    v_pk_fma_f32 v[172:173], v[172:173], v[230:231], v[230:231] op_sel:[0,1,0] op_sel_hi:[1,1,0]
    v_pk_fma_f32 v[174:175], v[174:175], v[230:231], v[230:231] op_sel:[0,1,0] op_sel_hi:[1,1,0]
    v_pk_mul_f32 v[64:65], v[64:65], v[152:153]
    v_rcp_f32 v156, v156
    v_pk_mul_f32 v[164:165], v[164:165], v[88:89]
    v_rcp_f32 v157, v157
    v_pk_mul_f32 v[166:167], v[166:167], v[90:91]
    v_pk_mul_f32 v[168:169], v[168:169], v[92:93]
    v_pk_mul_f32 v[66:67], v[66:67], v[154:155]
    v_rcp_f32 v158, v158
    v_pk_mul_f32 v[170:171], v[170:171], v[94:95]
    v_cvt_pk_bf16_f32 v124, v64, v65
    v_rcp_f32 v159, v159
    v_pk_mul_f32 v[172:173], v[172:173], v[96:97]
    v_pk_mul_f32 v[174:175], v[174:175], v[98:99]
    v_pk_mul_f32 v[68:69], v[68:69], v[156:157]
    v_rcp_f32 v160, v160
    v_pk_mul_f32 v[88:89], v[88:89], v[100:101]
    v_cvt_pk_bf16_f32 v125, v66, v67
    v_rcp_f32 v161, v161
    v_pk_mul_f32 v[90:91], v[90:91], v[102:103]
    v_pk_mul_f32 v[92:93], v[92:93], v[104:105]
    v_pk_mul_f32 v[70:71], v[70:71], v[158:159]
    v_rcp_f32 v162, v162
    v_pk_mul_f32 v[94:95], v[94:95], v[106:107]
    v_cvt_pk_bf16_f32 v128, v68, v69
    v_rcp_f32 v163, v163
    v_pk_mul_f32 v[96:97], v[96:97], v[108:109]
    v_pk_mul_f32 v[98:99], v[98:99], v[110:111]
    v_pk_mul_f32 v[72:73], v[72:73], v[160:161]
    v_cvt_pk_bf16_f32 v129, v70, v71
    v_pk_mul_f32 v[74:75], v[74:75], v[162:163]
    v_cvt_pk_bf16_f32 v132, v72, v73
    s_nop 0
    v_cvt_pk_bf16_f32 v133, v74, v75
    v_exp_f32 v164, v164
    v_exp_f32 v165, v165
    v_exp_f32 v166, v166
    v_exp_f32 v167, v167
    v_pk_fma_f32 v[164:165], v[164:165], v[228:229], v[228:229] op_sel:[0,1,1] op_sel_hi:[1,1,1]
    v_exp_f32 v168, v168
    v_exp_f32 v169, v169
    v_pk_fma_f32 v[166:167], v[166:167], v[228:229], v[228:229] op_sel:[0,1,1] op_sel_hi:[1,1,1]
    v_exp_f32 v170, v170
    v_exp_f32 v171, v171
    v_pk_fma_f32 v[168:169], v[168:169], v[228:229], v[228:229] op_sel:[0,1,1] op_sel_hi:[1,1,1]
    v_exp_f32 v172, v172
    v_exp_f32 v173, v173
    v_pk_fma_f32 v[170:171], v[170:171], v[228:229], v[228:229] op_sel:[0,1,1] op_sel_hi:[1,1,1]
    v_exp_f32 v174, v174
    v_exp_f32 v175, v175
    v_pk_fma_f32 v[172:173], v[172:173], v[228:229], v[228:229] op_sel:[0,1,1] op_sel_hi:[1,1,1]
    v_rcp_f32 v164, v164
    v_pk_fma_f32 v[174:175], v[174:175], v[228:229], v[228:229] op_sel:[0,1,1] op_sel_hi:[1,1,1]
    v_rcp_f32 v165, v165
    v_rcp_f32 v166, v166
    v_rcp_f32 v167, v167
    v_pk_mul_f32 v[88:89], v[88:89], v[164:165]
    v_rcp_f32 v168, v168
    v_rcp_f32 v169, v169
    v_pk_mul_f32 v[90:91], v[90:91], v[166:167]
    v_rcp_f32 v170, v170
    v_cvt_pk_bf16_f32 v126, v88, v89
    v_rcp_f32 v171, v171
    v_pk_mul_f32 v[92:93], v[92:93], v[168:169]
    v_rcp_f32 v172, v172
    v_cvt_pk_bf16_f32 v127, v90, v91
    v_rcp_f32 v173, v173
    v_pk_mul_f32 v[94:95], v[94:95], v[170:171]
    v_rcp_f32 v174, v174
    v_cvt_pk_bf16_f32 v130, v92, v93
    v_rcp_f32 v175, v175
    v_pk_mul_f32 v[96:97], v[96:97], v[172:173]
    v_cvt_pk_bf16_f32 v131, v94, v95
    v_pk_mul_f32 v[98:99], v[98:99], v[174:175]
    v_cvt_pk_bf16_f32 v134, v96, v97
    s_nop 0
    v_cvt_pk_bf16_f32 v135, v98, v99
    v_permlane16_swap_b32 v124, v126
    v_permlane16_swap_b32 v125, v127
    v_permlane16_swap_b32 v128, v130
    v_permlane16_swap_b32 v129, v131
    v_permlane16_swap_b32 v132, v134
    v_permlane16_swap_b32 v133, v135
    buffer_store_dwordx4 v[124:127], v12, s[24:27], s44 offen offset:2048 sc1
    buffer_store_dwordx4 v[128:131], v12, s[24:27], s45 offen offset:2048 sc1
    buffer_store_dwordx4 v[132:135], v12, s[24:27], s46 offen offset:2048 sc1
    v_lshlrev_b32 v2, 4, v0
    s_and_b32 s36, s28, 1
    s_lshr_b32 s37, s28, 1
    s_mul_i32 s10, s28, 5120
    v_add_u32 v3, s10, v2
    v_add_u32 v4, 61440, v3
    s_mul_i32 s43, s56, 196608
    s_lshl_b32 s10, s28, 12
    s_add_u32 s43, s43, s10
    s_add_u32 s43, s43, 13631488
    v_and_b32 v5, 15, v0
    v_lshrrev_b32 v6, 4, v0
    s_lshl_b32 s45, s37, 5
    s_add_u32 s45, s45, 64
    v_mul_u32_u24 v10, s45, v5
    v_lshl_add_u32 v10, v6, 3, v10
    s_mul_i32 s10, s28, 3072
    s_add_u32 s10, s10, 122880
    v_add_u32 v10, s10, v10
    v_add_u32 v11, s10, v2
    s_lshl_b32 s10, s56, 6
    s_lshl_b32 s11, s36, 5
    s_add_u32 s10, s10, s11
    s_mul_i32 s10, s10, 1280
    s_mul_i32 s11, s57, 160
    s_add_u32 s44, s10, s11
    s_lshl_b32 s11, s37, 6
    s_add_u32 s44, s44, s11
    s_movk_i32 s46, 16384
    s_cmp_eq_u32 s37, 1
    s_cselect_b32 s46, 10923, s46
    s_sub_u32 s45, 1280, s45
    v_add_u32 v8, 0, v0
    v_mul_u32_u24 v9, s46, v8
    v_lshrrev_b32 v9, 16, v9
    v_mul_u32_u24 v9, s45, v9
    v_lshl_add_u32 v12, v8, 4, v9
    v_add_u32 v8, 64, v0
    v_mul_u32_u24 v9, s46, v8
    v_lshrrev_b32 v9, 16, v9
    v_mul_u32_u24 v9, s45, v9
    v_lshl_add_u32 v13, v8, 4, v9
    v_add_u32 v8, 128, v0
    v_mul_u32_u24 v9, s46, v8
    v_lshrrev_b32 v9, 16, v9
    v_mul_u32_u24 v9, s45, v9
    v_lshl_add_u32 v14, v8, 4, v9
    v_mov_b32 v16, 0
    v_mov_b32 v17, 0
    v_mov_b32 v18, 0
    v_mov_b32 v19, 0
    v_mov_b32 v20, 0
    v_mov_b32 v21, 0
    v_mov_b32 v22, 0
    v_mov_b32 v23, 0
    v_mov_b32 v24, 0
    v_mov_b32 v25, 0
    v_mov_b32 v26, 0
    v_mov_b32 v27, 0
    v_mov_b32 v28, 0
    v_mov_b32 v29, 0
    v_mov_b32 v30, 0
    v_mov_b32 v31, 0
    v_mov_b32 v32, 0
    v_mov_b32 v33, 0
    v_mov_b32 v34, 0
    v_mov_b32 v35, 0
    v_mov_b32 v36, 0
    v_mov_b32 v37, 0
    v_mov_b32 v38, 0
    v_mov_b32 v39, 0
    v_mov_b32 v40, 0
    v_mov_b32 v41, 0
    v_mov_b32 v42, 0
    v_mov_b32 v43, 0
    v_mov_b32 v44, 0
    v_mov_b32 v45, 0
    v_mov_b32 v46, 0
    v_mov_b32 v47, 0
    v_mov_b32 v48, 0
    v_mov_b32 v49, 0
    v_mov_b32 v50, 0
    v_mov_b32 v51, 0
    v_mov_b32 v52, 0
    v_mov_b32 v53, 0
    v_mov_b32 v54, 0
    v_mov_b32 v55, 0
    v_mov_b32 v56, 0
    v_mov_b32 v57, 0
    v_mov_b32 v58, 0
    v_mov_b32 v59, 0
    v_mov_b32 v60, 0
    v_mov_b32 v61, 0
    v_mov_b32 v62, 0
    v_mov_b32 v63, 0
    v_mov_b32 v64, 0
    v_mov_b32 v65, 0
    v_mov_b32 v66, 0
    v_mov_b32 v67, 0
    v_mov_b32 v68, 0
    v_mov_b32 v69, 0
    v_mov_b32 v70, 0
    v_mov_b32 v71, 0
    v_mov_b32 v72, 0
    v_mov_b32 v73, 0
    v_mov_b32 v74, 0
    v_mov_b32 v75, 0
    v_mov_b32 v76, 0
    v_mov_b32 v77, 0
    v_mov_b32 v78, 0
    v_mov_b32 v79, 0
    v_mov_b32 v80, 0
    v_mov_b32 v81, 0
    v_mov_b32 v82, 0
    v_mov_b32 v83, 0
    v_mov_b32 v84, 0
    v_mov_b32 v85, 0
    v_mov_b32 v86, 0
    v_mov_b32 v87, 0
    v_mov_b32 v88, 0
    v_mov_b32 v89, 0
    v_mov_b32 v90, 0
    v_mov_b32 v91, 0
    v_mov_b32 v92, 0
    v_mov_b32 v93, 0
    v_mov_b32 v94, 0
    v_mov_b32 v95, 0
    s_mov_b32 s16, s52
    s_and_b32 s17, s53, 0xffff
    s_mov_b32 s18, 2621440
    s_mov_b32 s19, 0x00020000
    s_waitcnt vmcnt(0)
    s_barrier
    s_barrier
    buffer_load_dwordx4 v[96:99], v2, s[24:27], s43 offen offset:0 sc1
    buffer_load_dwordx4 v[100:103], v2, s[24:27], s43 offen offset:1024 sc1
    buffer_load_dwordx4 v[104:107], v2, s[24:27], s43 offen offset:2048 sc1
    buffer_load_dwordx4 v[108:111], v2, s[24:27], s43 offen offset:3072 sc1
    s_add_u32 s43, s43, 16384
    buffer_load_dwordx4 v[112:115], v2, s[24:27], s43 offen offset:0 sc1
    buffer_load_dwordx4 v[116:119], v2, s[24:27], s43 offen offset:1024 sc1
    buffer_load_dwordx4 v[120:123], v2, s[24:27], s43 offen offset:2048 sc1
    buffer_load_dwordx4 v[124:127], v2, s[24:27], s43 offen offset:3072 sc1
    s_add_u32 s43, s43, 16384
    buffer_load_dwordx4 v[128:131], v2, s[24:27], s43 offen offset:0 sc1
    buffer_load_dwordx4 v[132:135], v2, s[24:27], s43 offen offset:1024 sc1
    buffer_load_dwordx4 v[136:139], v2, s[24:27], s43 offen offset:2048 sc1
    buffer_load_dwordx4 v[140:143], v2, s[24:27], s43 offen offset:3072 sc1
    s_add_u32 s43, s43, 16384
    buffer_load_dwordx4 v[144:147], v2, s[24:27], s43 offen offset:0 sc1
    buffer_load_dwordx4 v[148:151], v2, s[24:27], s43 offen offset:1024 sc1
    buffer_load_dwordx4 v[152:155], v2, s[24:27], s43 offen offset:2048 sc1
    buffer_load_dwordx4 v[156:159], v2, s[24:27], s43 offen offset:3072 sc1
    s_add_u32 s43, s43, 16384
    ds_read_b128 v[160:163], v3 offset:0
    ds_read_b128 v[164:167], v3 offset:1024
    ds_read_b128 v[168:171], v3 offset:2048
    ds_read_b128 v[172:175], v3 offset:3072
    ds_read_b128 v[176:179], v3 offset:4096
    s_waitcnt vmcnt(12)
    s_waitcnt lgkmcnt(0)
    v_mfma_f32_16x16x32_bf16 v[16:19], v[160:163], v[96:99], v[16:19]
    s_barrier
    v_mfma_f32_16x16x32_bf16 v[20:23], v[164:167], v[96:99], v[20:23]
    ds_read_b128 v[180:183], v3 offset:20480
    v_mfma_f32_16x16x32_bf16 v[24:27], v[168:171], v[96:99], v[24:27]
    ds_read_b128 v[184:187], v3 offset:21504
    v_mfma_f32_16x16x32_bf16 v[28:31], v[172:175], v[96:99], v[28:31]
    ds_read_b128 v[188:191], v3 offset:22528
    v_mfma_f32_16x16x32_bf16 v[32:35], v[176:179], v[96:99], v[32:35]
    ds_read_b128 v[192:195], v3 offset:23552
    v_mfma_f32_16x16x32_bf16 v[36:39], v[160:163], v[100:103], v[36:39]
    ds_read_b128 v[196:199], v3 offset:24576
    v_mfma_f32_16x16x32_bf16 v[40:43], v[164:167], v[100:103], v[40:43]
    buffer_load_dwordx4 v[96:99], v2, s[24:27], s43 offen offset:0 sc1
    v_mfma_f32_16x16x32_bf16 v[44:47], v[168:171], v[100:103], v[44:47]
    v_mfma_f32_16x16x32_bf16 v[48:51], v[172:175], v[100:103], v[48:51]
    v_mfma_f32_16x16x32_bf16 v[52:55], v[176:179], v[100:103], v[52:55]
    v_mfma_f32_16x16x32_bf16 v[56:59], v[160:163], v[104:107], v[56:59]
    v_mfma_f32_16x16x32_bf16 v[60:63], v[164:167], v[104:107], v[60:63]
    buffer_load_dwordx4 v[100:103], v2, s[24:27], s43 offen offset:1024 sc1
    v_mfma_f32_16x16x32_bf16 v[64:67], v[168:171], v[104:107], v[64:67]
    v_mfma_f32_16x16x32_bf16 v[68:71], v[172:175], v[104:107], v[68:71]
    v_mfma_f32_16x16x32_bf16 v[72:75], v[176:179], v[104:107], v[72:75]
    v_mfma_f32_16x16x32_bf16 v[76:79], v[160:163], v[108:111], v[76:79]
    v_mfma_f32_16x16x32_bf16 v[80:83], v[164:167], v[108:111], v[80:83]
    buffer_load_dwordx4 v[104:107], v2, s[24:27], s43 offen offset:2048 sc1
    v_mfma_f32_16x16x32_bf16 v[84:87], v[168:171], v[108:111], v[84:87]
    v_mfma_f32_16x16x32_bf16 v[88:91], v[172:175], v[108:111], v[88:91]
    v_mfma_f32_16x16x32_bf16 v[92:95], v[176:179], v[108:111], v[92:95]
    buffer_load_dwordx4 v[108:111], v2, s[24:27], s43 offen offset:3072 sc1
    s_add_u32 s43, s43, 16384
    s_waitcnt vmcnt(12)
    s_waitcnt lgkmcnt(0)
    v_mfma_f32_16x16x32_bf16 v[16:19], v[180:183], v[112:115], v[16:19]
    s_barrier
    v_mfma_f32_16x16x32_bf16 v[20:23], v[184:187], v[112:115], v[20:23]
    ds_read_b128 v[160:163], v3 offset:40960
    v_mfma_f32_16x16x32_bf16 v[24:27], v[188:191], v[112:115], v[24:27]
    ds_read_b128 v[164:167], v3 offset:41984
    v_mfma_f32_16x16x32_bf16 v[28:31], v[192:195], v[112:115], v[28:31]
    ds_read_b128 v[168:171], v3 offset:43008
    v_mfma_f32_16x16x32_bf16 v[32:35], v[196:199], v[112:115], v[32:35]
    ds_read_b128 v[172:175], v3 offset:44032
    v_mfma_f32_16x16x32_bf16 v[36:39], v[180:183], v[116:119], v[36:39]
    ds_read_b128 v[176:179], v3 offset:45056
    v_mfma_f32_16x16x32_bf16 v[40:43], v[184:187], v[116:119], v[40:43]
    buffer_load_dwordx4 v[112:115], v2, s[24:27], s43 offen offset:0 sc1
    v_mfma_f32_16x16x32_bf16 v[44:47], v[188:191], v[116:119], v[44:47]
    v_mfma_f32_16x16x32_bf16 v[48:51], v[192:195], v[116:119], v[48:51]
    v_mfma_f32_16x16x32_bf16 v[52:55], v[196:199], v[116:119], v[52:55]
    v_mfma_f32_16x16x32_bf16 v[56:59], v[180:183], v[120:123], v[56:59]
    v_mfma_f32_16x16x32_bf16 v[60:63], v[184:187], v[120:123], v[60:63]
    buffer_load_dwordx4 v[116:119], v2, s[24:27], s43 offen offset:1024 sc1
    v_mfma_f32_16x16x32_bf16 v[64:67], v[188:191], v[120:123], v[64:67]
    v_mfma_f32_16x16x32_bf16 v[68:71], v[192:195], v[120:123], v[68:71]
    v_mfma_f32_16x16x32_bf16 v[72:75], v[196:199], v[120:123], v[72:75]
    v_mfma_f32_16x16x32_bf16 v[76:79], v[180:183], v[124:127], v[76:79]
    v_mfma_f32_16x16x32_bf16 v[80:83], v[184:187], v[124:127], v[80:83]
    buffer_load_dwordx4 v[120:123], v2, s[24:27], s43 offen offset:2048 sc1
    v_mfma_f32_16x16x32_bf16 v[84:87], v[188:191], v[124:127], v[84:87]
    v_mfma_f32_16x16x32_bf16 v[88:91], v[192:195], v[124:127], v[88:91]
    v_mfma_f32_16x16x32_bf16 v[92:95], v[196:199], v[124:127], v[92:95]
    buffer_load_dwordx4 v[124:127], v2, s[24:27], s43 offen offset:3072 sc1
    s_add_u32 s43, s43, 16384
    s_waitcnt vmcnt(12)
    s_waitcnt lgkmcnt(0)
    v_mfma_f32_16x16x32_bf16 v[16:19], v[160:163], v[128:131], v[16:19]
    s_barrier
    v_mfma_f32_16x16x32_bf16 v[20:23], v[164:167], v[128:131], v[20:23]
    ds_read_b128 v[180:183], v4 offset:0
    v_mfma_f32_16x16x32_bf16 v[24:27], v[168:171], v[128:131], v[24:27]
    ds_read_b128 v[184:187], v4 offset:1024
    v_mfma_f32_16x16x32_bf16 v[28:31], v[172:175], v[128:131], v[28:31]
    ds_read_b128 v[188:191], v4 offset:2048
    v_mfma_f32_16x16x32_bf16 v[32:35], v[176:179], v[128:131], v[32:35]
    ds_read_b128 v[192:195], v4 offset:3072
    v_mfma_f32_16x16x32_bf16 v[36:39], v[160:163], v[132:135], v[36:39]
    ds_read_b128 v[196:199], v4 offset:4096
    v_mfma_f32_16x16x32_bf16 v[40:43], v[164:167], v[132:135], v[40:43]
    buffer_load_dwordx4 v[128:131], v2, s[24:27], s43 offen offset:0 sc1
    v_mfma_f32_16x16x32_bf16 v[44:47], v[168:171], v[132:135], v[44:47]
    v_mfma_f32_16x16x32_bf16 v[48:51], v[172:175], v[132:135], v[48:51]
    v_mfma_f32_16x16x32_bf16 v[52:55], v[176:179], v[132:135], v[52:55]
    v_mfma_f32_16x16x32_bf16 v[56:59], v[160:163], v[136:139], v[56:59]
    v_mfma_f32_16x16x32_bf16 v[60:63], v[164:167], v[136:139], v[60:63]
    buffer_load_dwordx4 v[132:135], v2, s[24:27], s43 offen offset:1024 sc1
    v_mfma_f32_16x16x32_bf16 v[64:67], v[168:171], v[136:139], v[64:67]
    v_mfma_f32_16x16x32_bf16 v[68:71], v[172:175], v[136:139], v[68:71]
    v_mfma_f32_16x16x32_bf16 v[72:75], v[176:179], v[136:139], v[72:75]
    v_mfma_f32_16x16x32_bf16 v[76:79], v[160:163], v[140:143], v[76:79]
    v_mfma_f32_16x16x32_bf16 v[80:83], v[164:167], v[140:143], v[80:83]
    buffer_load_dwordx4 v[136:139], v2, s[24:27], s43 offen offset:2048 sc1
    v_mfma_f32_16x16x32_bf16 v[84:87], v[168:171], v[140:143], v[84:87]
    v_mfma_f32_16x16x32_bf16 v[88:91], v[172:175], v[140:143], v[88:91]
    v_mfma_f32_16x16x32_bf16 v[92:95], v[176:179], v[140:143], v[92:95]
    buffer_load_dwordx4 v[140:143], v2, s[24:27], s43 offen offset:3072 sc1
    s_add_u32 s43, s43, 16384
    s_waitcnt vmcnt(12)
    s_waitcnt lgkmcnt(0)
    v_mfma_f32_16x16x32_bf16 v[16:19], v[180:183], v[144:147], v[16:19]
    s_barrier
    v_mfma_f32_16x16x32_bf16 v[20:23], v[184:187], v[144:147], v[20:23]
    ds_read_b128 v[160:163], v4 offset:20480
    v_mfma_f32_16x16x32_bf16 v[24:27], v[188:191], v[144:147], v[24:27]
    ds_read_b128 v[164:167], v4 offset:21504
    v_mfma_f32_16x16x32_bf16 v[28:31], v[192:195], v[144:147], v[28:31]
    ds_read_b128 v[168:171], v4 offset:22528
    v_mfma_f32_16x16x32_bf16 v[32:35], v[196:199], v[144:147], v[32:35]
    ds_read_b128 v[172:175], v4 offset:23552
    v_mfma_f32_16x16x32_bf16 v[36:39], v[180:183], v[148:151], v[36:39]
    ds_read_b128 v[176:179], v4 offset:24576
    v_mfma_f32_16x16x32_bf16 v[40:43], v[184:187], v[148:151], v[40:43]
    buffer_load_dwordx4 v[144:147], v2, s[24:27], s43 offen offset:0 sc1
    v_mfma_f32_16x16x32_bf16 v[44:47], v[188:191], v[148:151], v[44:47]
    v_mfma_f32_16x16x32_bf16 v[48:51], v[192:195], v[148:151], v[48:51]
    v_mfma_f32_16x16x32_bf16 v[52:55], v[196:199], v[148:151], v[52:55]
    v_mfma_f32_16x16x32_bf16 v[56:59], v[180:183], v[152:155], v[56:59]
    v_mfma_f32_16x16x32_bf16 v[60:63], v[184:187], v[152:155], v[60:63]
    buffer_load_dwordx4 v[148:151], v2, s[24:27], s43 offen offset:1024 sc1
    v_mfma_f32_16x16x32_bf16 v[64:67], v[188:191], v[152:155], v[64:67]
    v_mfma_f32_16x16x32_bf16 v[68:71], v[192:195], v[152:155], v[68:71]
    v_mfma_f32_16x16x32_bf16 v[72:75], v[196:199], v[152:155], v[72:75]
    v_mfma_f32_16x16x32_bf16 v[76:79], v[180:183], v[156:159], v[76:79]
    v_mfma_f32_16x16x32_bf16 v[80:83], v[184:187], v[156:159], v[80:83]
    buffer_load_dwordx4 v[152:155], v2, s[24:27], s43 offen offset:2048 sc1
    v_mfma_f32_16x16x32_bf16 v[84:87], v[188:191], v[156:159], v[84:87]
    v_mfma_f32_16x16x32_bf16 v[88:91], v[192:195], v[156:159], v[88:91]
    v_mfma_f32_16x16x32_bf16 v[92:95], v[196:199], v[156:159], v[92:95]
    buffer_load_dwordx4 v[156:159], v2, s[24:27], s43 offen offset:3072 sc1
    s_add_u32 s43, s43, 16384
    s_waitcnt vmcnt(12)
    s_waitcnt lgkmcnt(0)
    v_mfma_f32_16x16x32_bf16 v[16:19], v[160:163], v[96:99], v[16:19]
    s_barrier
    v_mfma_f32_16x16x32_bf16 v[20:23], v[164:167], v[96:99], v[20:23]
    ds_read_b128 v[180:183], v4 offset:40960
    v_mfma_f32_16x16x32_bf16 v[24:27], v[168:171], v[96:99], v[24:27]
    ds_read_b128 v[184:187], v4 offset:41984
    v_mfma_f32_16x16x32_bf16 v[28:31], v[172:175], v[96:99], v[28:31]
    ds_read_b128 v[188:191], v4 offset:43008
    v_mfma_f32_16x16x32_bf16 v[32:35], v[176:179], v[96:99], v[32:35]
    ds_read_b128 v[192:195], v4 offset:44032
    v_mfma_f32_16x16x32_bf16 v[36:39], v[160:163], v[100:103], v[36:39]
    ds_read_b128 v[196:199], v4 offset:45056
    v_mfma_f32_16x16x32_bf16 v[40:43], v[164:167], v[100:103], v[40:43]
    buffer_load_dwordx4 v[96:99], v2, s[24:27], s43 offen offset:0 sc1
    v_mfma_f32_16x16x32_bf16 v[44:47], v[168:171], v[100:103], v[44:47]
    v_mfma_f32_16x16x32_bf16 v[48:51], v[172:175], v[100:103], v[48:51]
    v_mfma_f32_16x16x32_bf16 v[52:55], v[176:179], v[100:103], v[52:55]
    v_mfma_f32_16x16x32_bf16 v[56:59], v[160:163], v[104:107], v[56:59]
    v_mfma_f32_16x16x32_bf16 v[60:63], v[164:167], v[104:107], v[60:63]
    buffer_load_dwordx4 v[100:103], v2, s[24:27], s43 offen offset:1024 sc1
    v_mfma_f32_16x16x32_bf16 v[64:67], v[168:171], v[104:107], v[64:67]
    v_mfma_f32_16x16x32_bf16 v[68:71], v[172:175], v[104:107], v[68:71]
    v_mfma_f32_16x16x32_bf16 v[72:75], v[176:179], v[104:107], v[72:75]
    v_mfma_f32_16x16x32_bf16 v[76:79], v[160:163], v[108:111], v[76:79]
    v_mfma_f32_16x16x32_bf16 v[80:83], v[164:167], v[108:111], v[80:83]
    buffer_load_dwordx4 v[104:107], v2, s[24:27], s43 offen offset:2048 sc1
    v_mfma_f32_16x16x32_bf16 v[84:87], v[168:171], v[108:111], v[84:87]
    v_mfma_f32_16x16x32_bf16 v[88:91], v[172:175], v[108:111], v[88:91]
    v_mfma_f32_16x16x32_bf16 v[92:95], v[176:179], v[108:111], v[92:95]
    buffer_load_dwordx4 v[108:111], v2, s[24:27], s43 offen offset:3072 sc1
    s_add_u32 s43, s43, 16384
    s_waitcnt vmcnt(12)
    s_waitcnt lgkmcnt(0)
    v_mfma_f32_16x16x32_bf16 v[16:19], v[180:183], v[112:115], v[16:19]
    s_barrier
    v_mfma_f32_16x16x32_bf16 v[20:23], v[184:187], v[112:115], v[20:23]
    ds_read_b128 v[160:163], v3 offset:0
    v_mfma_f32_16x16x32_bf16 v[24:27], v[188:191], v[112:115], v[24:27]
    ds_read_b128 v[164:167], v3 offset:1024
    v_mfma_f32_16x16x32_bf16 v[28:31], v[192:195], v[112:115], v[28:31]
    ds_read_b128 v[168:171], v3 offset:2048
    v_mfma_f32_16x16x32_bf16 v[32:35], v[196:199], v[112:115], v[32:35]
    ds_read_b128 v[172:175], v3 offset:3072
    v_mfma_f32_16x16x32_bf16 v[36:39], v[180:183], v[116:119], v[36:39]
    ds_read_b128 v[176:179], v3 offset:4096
    v_mfma_f32_16x16x32_bf16 v[40:43], v[184:187], v[116:119], v[40:43]
    buffer_load_dwordx4 v[112:115], v2, s[24:27], s43 offen offset:0 sc1
    v_mfma_f32_16x16x32_bf16 v[44:47], v[188:191], v[116:119], v[44:47]
    v_mfma_f32_16x16x32_bf16 v[48:51], v[192:195], v[116:119], v[48:51]
    v_mfma_f32_16x16x32_bf16 v[52:55], v[196:199], v[116:119], v[52:55]
    v_mfma_f32_16x16x32_bf16 v[56:59], v[180:183], v[120:123], v[56:59]
    v_mfma_f32_16x16x32_bf16 v[60:63], v[184:187], v[120:123], v[60:63]
    buffer_load_dwordx4 v[116:119], v2, s[24:27], s43 offen offset:1024 sc1
    v_mfma_f32_16x16x32_bf16 v[64:67], v[188:191], v[120:123], v[64:67]
    v_mfma_f32_16x16x32_bf16 v[68:71], v[192:195], v[120:123], v[68:71]
    v_mfma_f32_16x16x32_bf16 v[72:75], v[196:199], v[120:123], v[72:75]
    v_mfma_f32_16x16x32_bf16 v[76:79], v[180:183], v[124:127], v[76:79]
    v_mfma_f32_16x16x32_bf16 v[80:83], v[184:187], v[124:127], v[80:83]
    buffer_load_dwordx4 v[120:123], v2, s[24:27], s43 offen offset:2048 sc1
    v_mfma_f32_16x16x32_bf16 v[84:87], v[188:191], v[124:127], v[84:87]
    v_mfma_f32_16x16x32_bf16 v[88:91], v[192:195], v[124:127], v[88:91]
    v_mfma_f32_16x16x32_bf16 v[92:95], v[196:199], v[124:127], v[92:95]
    buffer_load_dwordx4 v[124:127], v2, s[24:27], s43 offen offset:3072 sc1
    s_add_u32 s43, s43, 16384
    s_waitcnt vmcnt(12)
    s_waitcnt lgkmcnt(0)
    v_mfma_f32_16x16x32_bf16 v[16:19], v[160:163], v[128:131], v[16:19]
    s_barrier
    v_mfma_f32_16x16x32_bf16 v[20:23], v[164:167], v[128:131], v[20:23]
    ds_read_b128 v[180:183], v3 offset:20480
    v_mfma_f32_16x16x32_bf16 v[24:27], v[168:171], v[128:131], v[24:27]
    ds_read_b128 v[184:187], v3 offset:21504
    v_mfma_f32_16x16x32_bf16 v[28:31], v[172:175], v[128:131], v[28:31]
    ds_read_b128 v[188:191], v3 offset:22528
    v_mfma_f32_16x16x32_bf16 v[32:35], v[176:179], v[128:131], v[32:35]
    ds_read_b128 v[192:195], v3 offset:23552
    v_mfma_f32_16x16x32_bf16 v[36:39], v[160:163], v[132:135], v[36:39]
    ds_read_b128 v[196:199], v3 offset:24576
    v_mfma_f32_16x16x32_bf16 v[40:43], v[164:167], v[132:135], v[40:43]
    buffer_load_dwordx4 v[128:131], v2, s[24:27], s43 offen offset:0 sc1
    v_mfma_f32_16x16x32_bf16 v[44:47], v[168:171], v[132:135], v[44:47]
    v_mfma_f32_16x16x32_bf16 v[48:51], v[172:175], v[132:135], v[48:51]
    v_mfma_f32_16x16x32_bf16 v[52:55], v[176:179], v[132:135], v[52:55]
    v_mfma_f32_16x16x32_bf16 v[56:59], v[160:163], v[136:139], v[56:59]
    v_mfma_f32_16x16x32_bf16 v[60:63], v[164:167], v[136:139], v[60:63]
    buffer_load_dwordx4 v[132:135], v2, s[24:27], s43 offen offset:1024 sc1
    v_mfma_f32_16x16x32_bf16 v[64:67], v[168:171], v[136:139], v[64:67]
    v_mfma_f32_16x16x32_bf16 v[68:71], v[172:175], v[136:139], v[68:71]
    v_mfma_f32_16x16x32_bf16 v[72:75], v[176:179], v[136:139], v[72:75]
    v_mfma_f32_16x16x32_bf16 v[76:79], v[160:163], v[140:143], v[76:79]
    v_mfma_f32_16x16x32_bf16 v[80:83], v[164:167], v[140:143], v[80:83]
    buffer_load_dwordx4 v[136:139], v2, s[24:27], s43 offen offset:2048 sc1
    v_mfma_f32_16x16x32_bf16 v[84:87], v[168:171], v[140:143], v[84:87]
    v_mfma_f32_16x16x32_bf16 v[88:91], v[172:175], v[140:143], v[88:91]
    v_mfma_f32_16x16x32_bf16 v[92:95], v[176:179], v[140:143], v[92:95]
    buffer_load_dwordx4 v[140:143], v2, s[24:27], s43 offen offset:3072 sc1
    s_add_u32 s43, s43, 16384
    s_waitcnt vmcnt(12)
    s_waitcnt lgkmcnt(0)
    v_mfma_f32_16x16x32_bf16 v[16:19], v[180:183], v[144:147], v[16:19]
    s_barrier
    v_mfma_f32_16x16x32_bf16 v[20:23], v[184:187], v[144:147], v[20:23]
    ds_read_b128 v[160:163], v3 offset:40960
    v_mfma_f32_16x16x32_bf16 v[24:27], v[188:191], v[144:147], v[24:27]
    ds_read_b128 v[164:167], v3 offset:41984
    v_mfma_f32_16x16x32_bf16 v[28:31], v[192:195], v[144:147], v[28:31]
    ds_read_b128 v[168:171], v3 offset:43008
    v_mfma_f32_16x16x32_bf16 v[32:35], v[196:199], v[144:147], v[32:35]
    ds_read_b128 v[172:175], v3 offset:44032
    v_mfma_f32_16x16x32_bf16 v[36:39], v[180:183], v[148:151], v[36:39]
    ds_read_b128 v[176:179], v3 offset:45056
    v_mfma_f32_16x16x32_bf16 v[40:43], v[184:187], v[148:151], v[40:43]
    buffer_load_dwordx4 v[144:147], v2, s[24:27], s43 offen offset:0 sc1
    v_mfma_f32_16x16x32_bf16 v[44:47], v[188:191], v[148:151], v[44:47]
    v_mfma_f32_16x16x32_bf16 v[48:51], v[192:195], v[148:151], v[48:51]
    v_mfma_f32_16x16x32_bf16 v[52:55], v[196:199], v[148:151], v[52:55]
    v_mfma_f32_16x16x32_bf16 v[56:59], v[180:183], v[152:155], v[56:59]
    v_mfma_f32_16x16x32_bf16 v[60:63], v[184:187], v[152:155], v[60:63]
    buffer_load_dwordx4 v[148:151], v2, s[24:27], s43 offen offset:1024 sc1
    v_mfma_f32_16x16x32_bf16 v[64:67], v[188:191], v[152:155], v[64:67]
    v_mfma_f32_16x16x32_bf16 v[68:71], v[192:195], v[152:155], v[68:71]
    v_mfma_f32_16x16x32_bf16 v[72:75], v[196:199], v[152:155], v[72:75]
    v_mfma_f32_16x16x32_bf16 v[76:79], v[180:183], v[156:159], v[76:79]
    v_mfma_f32_16x16x32_bf16 v[80:83], v[184:187], v[156:159], v[80:83]
    buffer_load_dwordx4 v[152:155], v2, s[24:27], s43 offen offset:2048 sc1
    v_mfma_f32_16x16x32_bf16 v[84:87], v[188:191], v[156:159], v[84:87]
    v_mfma_f32_16x16x32_bf16 v[88:91], v[192:195], v[156:159], v[88:91]
    v_mfma_f32_16x16x32_bf16 v[92:95], v[196:199], v[156:159], v[92:95]
    buffer_load_dwordx4 v[156:159], v2, s[24:27], s43 offen offset:3072 sc1
    s_add_u32 s43, s43, 16384
    s_waitcnt vmcnt(12)
    s_waitcnt lgkmcnt(0)
    v_mfma_f32_16x16x32_bf16 v[16:19], v[160:163], v[96:99], v[16:19]
    s_barrier
    v_mfma_f32_16x16x32_bf16 v[20:23], v[164:167], v[96:99], v[20:23]
    ds_read_b128 v[180:183], v4 offset:0
    v_mfma_f32_16x16x32_bf16 v[24:27], v[168:171], v[96:99], v[24:27]
    ds_read_b128 v[184:187], v4 offset:1024
    v_mfma_f32_16x16x32_bf16 v[28:31], v[172:175], v[96:99], v[28:31]
    ds_read_b128 v[188:191], v4 offset:2048
    v_mfma_f32_16x16x32_bf16 v[32:35], v[176:179], v[96:99], v[32:35]
    ds_read_b128 v[192:195], v4 offset:3072
    v_mfma_f32_16x16x32_bf16 v[36:39], v[160:163], v[100:103], v[36:39]
    ds_read_b128 v[196:199], v4 offset:4096
    v_mfma_f32_16x16x32_bf16 v[40:43], v[164:167], v[100:103], v[40:43]
    v_mfma_f32_16x16x32_bf16 v[44:47], v[168:171], v[100:103], v[44:47]
    v_mfma_f32_16x16x32_bf16 v[48:51], v[172:175], v[100:103], v[48:51]
    v_mfma_f32_16x16x32_bf16 v[52:55], v[176:179], v[100:103], v[52:55]
    v_mfma_f32_16x16x32_bf16 v[56:59], v[160:163], v[104:107], v[56:59]
    v_mfma_f32_16x16x32_bf16 v[60:63], v[164:167], v[104:107], v[60:63]
    v_mfma_f32_16x16x32_bf16 v[64:67], v[168:171], v[104:107], v[64:67]
    v_mfma_f32_16x16x32_bf16 v[68:71], v[172:175], v[104:107], v[68:71]
    v_mfma_f32_16x16x32_bf16 v[72:75], v[176:179], v[104:107], v[72:75]
    v_mfma_f32_16x16x32_bf16 v[76:79], v[160:163], v[108:111], v[76:79]
    v_mfma_f32_16x16x32_bf16 v[80:83], v[164:167], v[108:111], v[80:83]
    v_mfma_f32_16x16x32_bf16 v[84:87], v[168:171], v[108:111], v[84:87]
    v_mfma_f32_16x16x32_bf16 v[88:91], v[172:175], v[108:111], v[88:91]
    v_mfma_f32_16x16x32_bf16 v[92:95], v[176:179], v[108:111], v[92:95]
    s_waitcnt vmcnt(8)
    s_waitcnt lgkmcnt(0)
    v_mfma_f32_16x16x32_bf16 v[16:19], v[180:183], v[112:115], v[16:19]
    s_barrier
    v_mfma_f32_16x16x32_bf16 v[20:23], v[184:187], v[112:115], v[20:23]
    ds_read_b128 v[160:163], v4 offset:20480
    v_mfma_f32_16x16x32_bf16 v[24:27], v[188:191], v[112:115], v[24:27]
    ds_read_b128 v[164:167], v4 offset:21504
    v_mfma_f32_16x16x32_bf16 v[28:31], v[192:195], v[112:115], v[28:31]
    ds_read_b128 v[168:171], v4 offset:22528
    v_mfma_f32_16x16x32_bf16 v[32:35], v[196:199], v[112:115], v[32:35]
    ds_read_b128 v[172:175], v4 offset:23552
    v_mfma_f32_16x16x32_bf16 v[36:39], v[180:183], v[116:119], v[36:39]
    ds_read_b128 v[176:179], v4 offset:24576
    v_mfma_f32_16x16x32_bf16 v[40:43], v[184:187], v[116:119], v[40:43]
    v_mfma_f32_16x16x32_bf16 v[44:47], v[188:191], v[116:119], v[44:47]
    v_mfma_f32_16x16x32_bf16 v[48:51], v[192:195], v[116:119], v[48:51]
    v_mfma_f32_16x16x32_bf16 v[52:55], v[196:199], v[116:119], v[52:55]
    v_mfma_f32_16x16x32_bf16 v[56:59], v[180:183], v[120:123], v[56:59]
    v_mfma_f32_16x16x32_bf16 v[60:63], v[184:187], v[120:123], v[60:63]
    v_mfma_f32_16x16x32_bf16 v[64:67], v[188:191], v[120:123], v[64:67]
    v_mfma_f32_16x16x32_bf16 v[68:71], v[192:195], v[120:123], v[68:71]
    v_mfma_f32_16x16x32_bf16 v[72:75], v[196:199], v[120:123], v[72:75]
    v_mfma_f32_16x16x32_bf16 v[76:79], v[180:183], v[124:127], v[76:79]
    v_mfma_f32_16x16x32_bf16 v[80:83], v[184:187], v[124:127], v[80:83]
    v_mfma_f32_16x16x32_bf16 v[84:87], v[188:191], v[124:127], v[84:87]
    v_mfma_f32_16x16x32_bf16 v[88:91], v[192:195], v[124:127], v[88:91]
    v_mfma_f32_16x16x32_bf16 v[92:95], v[196:199], v[124:127], v[92:95]
    s_waitcnt vmcnt(4)
    s_waitcnt lgkmcnt(0)
    v_mfma_f32_16x16x32_bf16 v[16:19], v[160:163], v[128:131], v[16:19]
    s_barrier
    v_mfma_f32_16x16x32_bf16 v[20:23], v[164:167], v[128:131], v[20:23]
    ds_read_b128 v[180:183], v4 offset:40960
    v_mfma_f32_16x16x32_bf16 v[24:27], v[168:171], v[128:131], v[24:27]
    ds_read_b128 v[184:187], v4 offset:41984
    v_mfma_f32_16x16x32_bf16 v[28:31], v[172:175], v[128:131], v[28:31]
    ds_read_b128 v[188:191], v4 offset:43008
    v_mfma_f32_16x16x32_bf16 v[32:35], v[176:179], v[128:131], v[32:35]
    ds_read_b128 v[192:195], v4 offset:44032
    v_mfma_f32_16x16x32_bf16 v[36:39], v[160:163], v[132:135], v[36:39]
    ds_read_b128 v[196:199], v4 offset:45056
    v_mfma_f32_16x16x32_bf16 v[40:43], v[164:167], v[132:135], v[40:43]
    v_mfma_f32_16x16x32_bf16 v[44:47], v[168:171], v[132:135], v[44:47]
    v_mfma_f32_16x16x32_bf16 v[48:51], v[172:175], v[132:135], v[48:51]
    v_mfma_f32_16x16x32_bf16 v[52:55], v[176:179], v[132:135], v[52:55]
    v_mfma_f32_16x16x32_bf16 v[56:59], v[160:163], v[136:139], v[56:59]
    v_mfma_f32_16x16x32_bf16 v[60:63], v[164:167], v[136:139], v[60:63]
    v_mfma_f32_16x16x32_bf16 v[64:67], v[168:171], v[136:139], v[64:67]
    v_mfma_f32_16x16x32_bf16 v[68:71], v[172:175], v[136:139], v[68:71]
    v_mfma_f32_16x16x32_bf16 v[72:75], v[176:179], v[136:139], v[72:75]
    v_mfma_f32_16x16x32_bf16 v[76:79], v[160:163], v[140:143], v[76:79]
    v_mfma_f32_16x16x32_bf16 v[80:83], v[164:167], v[140:143], v[80:83]
    v_mfma_f32_16x16x32_bf16 v[84:87], v[168:171], v[140:143], v[84:87]
    v_mfma_f32_16x16x32_bf16 v[88:91], v[172:175], v[140:143], v[88:91]
    v_mfma_f32_16x16x32_bf16 v[92:95], v[176:179], v[140:143], v[92:95]
    s_waitcnt vmcnt(0)
    s_waitcnt lgkmcnt(0)
    s_cmp_eq_u32 s28, 1
    s_cbranch_scc1 DN_w1
    s_cmp_eq_u32 s28, 2
    s_cbranch_scc1 DN_w2
    s_cmp_eq_u32 s28, 3
    s_cbranch_scc1 DN_w3
    v_mfma_f32_16x16x32_bf16 v[24:27], v[188:191], v[144:147], v[24:27]
    v_mfma_f32_16x16x32_bf16 v[28:31], v[192:195], v[144:147], v[28:31]
    v_mfma_f32_16x16x32_bf16 v[32:35], v[196:199], v[144:147], v[32:35]
    v_mfma_f32_16x16x32_bf16 v[44:47], v[188:191], v[148:151], v[44:47]
    v_mfma_f32_16x16x32_bf16 v[48:51], v[192:195], v[148:151], v[48:51]
    v_mfma_f32_16x16x32_bf16 v[52:55], v[196:199], v[148:151], v[52:55]
    s_nop 2
    ds_write_b128 v2, v[24:27] offset:6144
    v_mfma_f32_16x16x32_bf16 v[56:59], v[180:183], v[152:155], v[56:59]
    s_nop 2
    ds_write_b128 v2, v[28:31] offset:9216
    v_mfma_f32_16x16x32_bf16 v[60:63], v[184:187], v[152:155], v[60:63]
    s_nop 2
    ds_write_b128 v2, v[32:35] offset:12288
    v_mfma_f32_16x16x32_bf16 v[64:67], v[188:191], v[152:155], v[64:67]
    s_nop 2
    ds_write_b128 v2, v[44:47] offset:21504
    v_mfma_f32_16x16x32_bf16 v[68:71], v[192:195], v[152:155], v[68:71]
    s_nop 2
    ds_write_b128 v2, v[48:51] offset:24576
    v_mfma_f32_16x16x32_bf16 v[72:75], v[196:199], v[152:155], v[72:75]
    s_nop 2
    ds_write_b128 v2, v[52:55] offset:27648
    v_mfma_f32_16x16x32_bf16 v[76:79], v[180:183], v[156:159], v[76:79]
    s_nop 2
    ds_write_b128 v2, v[56:59] offset:30720
    v_mfma_f32_16x16x32_bf16 v[80:83], v[184:187], v[156:159], v[80:83]
    s_nop 2
    ds_write_b128 v2, v[60:63] offset:33792
    v_mfma_f32_16x16x32_bf16 v[84:87], v[188:191], v[156:159], v[84:87]
    s_nop 2
    ds_write_b128 v2, v[64:67] offset:36864
    v_mfma_f32_16x16x32_bf16 v[88:91], v[192:195], v[156:159], v[88:91]
    s_nop 2
    ds_write_b128 v2, v[68:71] offset:39936
    v_mfma_f32_16x16x32_bf16 v[92:95], v[196:199], v[156:159], v[92:95]
    s_nop 2
    ds_write_b128 v2, v[72:75] offset:43008
    v_mfma_f32_16x16x32_bf16 v[16:19], v[180:183], v[144:147], v[16:19]
    s_nop 2
    ds_write_b128 v2, v[76:79] offset:46080
    v_mfma_f32_16x16x32_bf16 v[20:23], v[184:187], v[144:147], v[20:23]
    s_nop 2
    ds_write_b128 v2, v[80:83] offset:49152
    v_mfma_f32_16x16x32_bf16 v[36:39], v[180:183], v[148:151], v[36:39]
    s_nop 2
    ds_write_b128 v2, v[84:87] offset:52224
    v_mfma_f32_16x16x32_bf16 v[40:43], v[184:187], v[148:151], v[40:43]
    s_nop 2
    ds_write_b128 v2, v[88:91] offset:55296
    s_nop 3
    ds_write_b128 v2, v[92:95] offset:58368
    s_waitcnt lgkmcnt(0)
    s_barrier
    ds_read_b128 v[96:99], v2 offset:0
    ds_read_b128 v[100:103], v2 offset:1024
    ds_read_b128 v[104:107], v2 offset:2048
    ds_read_b128 v[108:111], v2 offset:3072
    ds_read_b128 v[112:115], v2 offset:4096
    ds_read_b128 v[116:119], v2 offset:5120
    ds_read_b128 v[120:123], v2 offset:15360
    ds_read_b128 v[124:127], v2 offset:16384
    ds_read_b128 v[128:131], v2 offset:17408
    ds_read_b128 v[132:135], v2 offset:18432
    ds_read_b128 v[136:139], v2 offset:19456
    ds_read_b128 v[140:143], v2 offset:20480
    v_lshlrev_b32 v200, 16, v232
    v_and_b32 v201, 0xffff0000, v232
    v_lshlrev_b32 v202, 16, v233
    v_and_b32 v203, 0xffff0000, v233
    v_pk_add_f32 v[16:17], v[16:17], v[200:201]
    v_pk_add_f32 v[18:19], v[18:19], v[202:203]
    v_lshlrev_b32 v200, 16, v236
    v_and_b32 v201, 0xffff0000, v236
    v_lshlrev_b32 v202, 16, v237
    v_and_b32 v203, 0xffff0000, v237
    v_pk_add_f32 v[20:21], v[20:21], v[200:201]
    v_pk_add_f32 v[22:23], v[22:23], v[202:203]
    v_lshlrev_b32 v200, 16, v234
    v_and_b32 v201, 0xffff0000, v234
    v_lshlrev_b32 v202, 16, v235
    v_and_b32 v203, 0xffff0000, v235
    v_pk_add_f32 v[36:37], v[36:37], v[200:201]
    v_pk_add_f32 v[38:39], v[38:39], v[202:203]
    v_lshlrev_b32 v200, 16, v238
    v_and_b32 v201, 0xffff0000, v238
    v_lshlrev_b32 v202, 16, v239
    v_and_b32 v203, 0xffff0000, v239
    v_pk_add_f32 v[40:41], v[40:41], v[200:201]
    v_pk_add_f32 v[42:43], v[42:43], v[202:203]
    s_waitcnt lgkmcnt(0)
    v_pk_add_f32 v[96:97], v[96:97], v[100:101]
    v_pk_add_f32 v[98:99], v[98:99], v[102:103]
    v_pk_add_f32 v[16:17], v[16:17], v[104:105]
    v_pk_add_f32 v[18:19], v[18:19], v[106:107]
    v_pk_add_f32 v[16:17], v[16:17], v[96:97]
    v_pk_add_f32 v[18:19], v[18:19], v[98:99]
    v_cvt_pk_bf16_f32 v232, v16, v17
    v_cvt_pk_bf16_f32 v233, v18, v19
    ds_write_b64 v10, v[232:233] offset:0
    v_pk_add_f32 v[108:109], v[108:109], v[112:113]
    v_pk_add_f32 v[110:111], v[110:111], v[114:115]
    v_pk_add_f32 v[20:21], v[20:21], v[116:117]
    v_pk_add_f32 v[22:23], v[22:23], v[118:119]
    v_pk_add_f32 v[20:21], v[20:21], v[108:109]
    v_pk_add_f32 v[22:23], v[22:23], v[110:111]
    v_cvt_pk_bf16_f32 v236, v20, v21
    v_cvt_pk_bf16_f32 v237, v22, v23
    ds_write_b64 v10, v[236:237] offset:32
    v_pk_add_f32 v[120:121], v[120:121], v[124:125]
    v_pk_add_f32 v[122:123], v[122:123], v[126:127]
    v_pk_add_f32 v[36:37], v[36:37], v[128:129]
    v_pk_add_f32 v[38:39], v[38:39], v[130:131]
    v_pk_add_f32 v[36:37], v[36:37], v[120:121]
    v_pk_add_f32 v[38:39], v[38:39], v[122:123]
    v_cvt_pk_bf16_f32 v234, v36, v37
    v_cvt_pk_bf16_f32 v235, v38, v39
    ds_write_b64 v10, v[234:235] offset:1024
    v_pk_add_f32 v[132:133], v[132:133], v[136:137]
    v_pk_add_f32 v[134:135], v[134:135], v[138:139]
    v_pk_add_f32 v[40:41], v[40:41], v[140:141]
    v_pk_add_f32 v[42:43], v[42:43], v[142:143]
    v_pk_add_f32 v[40:41], v[40:41], v[132:133]
    v_pk_add_f32 v[42:43], v[42:43], v[134:135]
    v_cvt_pk_bf16_f32 v238, v40, v41
    v_cvt_pk_bf16_f32 v239, v42, v43
    ds_write_b64 v10, v[238:239] offset:1056
    s_waitcnt lgkmcnt(0)
    ds_read_b128 v[204:207], v11 offset:0
    ds_read_b128 v[208:211], v11 offset:1024
    s_waitcnt lgkmcnt(1)
    buffer_store_dwordx4 v[204:207], v12, s[16:19], s44 offen
    s_waitcnt lgkmcnt(0)
    buffer_store_dwordx4 v[208:211], v13, s[16:19], s44 offen
    s_branch DN_done
DN_w1:
    v_mfma_f32_16x16x32_bf16 v[16:19], v[180:183], v[144:147], v[16:19]
    v_mfma_f32_16x16x32_bf16 v[20:23], v[184:187], v[144:147], v[20:23]
    v_mfma_f32_16x16x32_bf16 v[24:27], v[188:191], v[144:147], v[24:27]
    v_mfma_f32_16x16x32_bf16 v[28:31], v[192:195], v[144:147], v[28:31]
    v_mfma_f32_16x16x32_bf16 v[32:35], v[196:199], v[144:147], v[32:35]
    v_mfma_f32_16x16x32_bf16 v[36:39], v[180:183], v[148:151], v[36:39]
    s_nop 2
    ds_write_b128 v2, v[16:19] offset:0
    v_mfma_f32_16x16x32_bf16 v[40:43], v[184:187], v[148:151], v[40:43]
    s_nop 2
    ds_write_b128 v2, v[20:23] offset:3072
    v_mfma_f32_16x16x32_bf16 v[44:47], v[188:191], v[148:151], v[44:47]
    s_nop 2
    ds_write_b128 v2, v[24:27] offset:7168
    v_mfma_f32_16x16x32_bf16 v[48:51], v[192:195], v[148:151], v[48:51]
    s_nop 2
    ds_write_b128 v2, v[28:31] offset:10240
    v_mfma_f32_16x16x32_bf16 v[52:55], v[196:199], v[148:151], v[52:55]
    s_nop 2
    ds_write_b128 v2, v[32:35] offset:13312
    v_mfma_f32_16x16x32_bf16 v[64:67], v[188:191], v[152:155], v[64:67]
    s_nop 2
    ds_write_b128 v2, v[36:39] offset:15360
    v_mfma_f32_16x16x32_bf16 v[68:71], v[192:195], v[152:155], v[68:71]
    s_nop 2
    ds_write_b128 v2, v[40:43] offset:18432
    v_mfma_f32_16x16x32_bf16 v[72:75], v[196:199], v[152:155], v[72:75]
    s_nop 2
    ds_write_b128 v2, v[44:47] offset:22528
    v_mfma_f32_16x16x32_bf16 v[84:87], v[188:191], v[156:159], v[84:87]
    s_nop 2
    ds_write_b128 v2, v[48:51] offset:25600
    v_mfma_f32_16x16x32_bf16 v[88:91], v[192:195], v[156:159], v[88:91]
    s_nop 2
    ds_write_b128 v2, v[52:55] offset:28672
    v_mfma_f32_16x16x32_bf16 v[92:95], v[196:199], v[156:159], v[92:95]
    s_nop 2
    ds_write_b128 v2, v[64:67] offset:37888
    v_mfma_f32_16x16x32_bf16 v[56:59], v[180:183], v[152:155], v[56:59]
    s_nop 2
    ds_write_b128 v2, v[68:71] offset:40960
    v_mfma_f32_16x16x32_bf16 v[60:63], v[184:187], v[152:155], v[60:63]
    s_nop 2
    ds_write_b128 v2, v[72:75] offset:44032
    v_mfma_f32_16x16x32_bf16 v[76:79], v[180:183], v[156:159], v[76:79]
    s_nop 2
    ds_write_b128 v2, v[84:87] offset:53248
    v_mfma_f32_16x16x32_bf16 v[80:83], v[184:187], v[156:159], v[80:83]
    s_nop 2
    ds_write_b128 v2, v[88:91] offset:56320
    s_nop 3
    ds_write_b128 v2, v[92:95] offset:59392
    s_waitcnt lgkmcnt(0)
    s_barrier
    ds_read_b128 v[96:99], v2 offset:30720
    ds_read_b128 v[100:103], v2 offset:31744
    ds_read_b128 v[104:107], v2 offset:32768
    ds_read_b128 v[108:111], v2 offset:33792
    ds_read_b128 v[112:115], v2 offset:34816
    ds_read_b128 v[116:119], v2 offset:35840
    ds_read_b128 v[120:123], v2 offset:46080
    ds_read_b128 v[124:127], v2 offset:47104
    ds_read_b128 v[128:131], v2 offset:48128
    ds_read_b128 v[132:135], v2 offset:49152
    ds_read_b128 v[136:139], v2 offset:50176
    ds_read_b128 v[140:143], v2 offset:51200
    v_lshlrev_b32 v200, 16, v232
    v_and_b32 v201, 0xffff0000, v232
    v_lshlrev_b32 v202, 16, v233
    v_and_b32 v203, 0xffff0000, v233
    v_pk_add_f32 v[56:57], v[56:57], v[200:201]
    v_pk_add_f32 v[58:59], v[58:59], v[202:203]
    v_lshlrev_b32 v200, 16, v236
    v_and_b32 v201, 0xffff0000, v236
    v_lshlrev_b32 v202, 16, v237
    v_and_b32 v203, 0xffff0000, v237
    v_pk_add_f32 v[60:61], v[60:61], v[200:201]
    v_pk_add_f32 v[62:63], v[62:63], v[202:203]
    v_lshlrev_b32 v200, 16, v234
    v_and_b32 v201, 0xffff0000, v234
    v_lshlrev_b32 v202, 16, v235
    v_and_b32 v203, 0xffff0000, v235
    v_pk_add_f32 v[76:77], v[76:77], v[200:201]
    v_pk_add_f32 v[78:79], v[78:79], v[202:203]
    v_lshlrev_b32 v200, 16, v238
    v_and_b32 v201, 0xffff0000, v238
    v_lshlrev_b32 v202, 16, v239
    v_and_b32 v203, 0xffff0000, v239
    v_pk_add_f32 v[80:81], v[80:81], v[200:201]
    v_pk_add_f32 v[82:83], v[82:83], v[202:203]
    s_waitcnt lgkmcnt(0)
    v_pk_add_f32 v[96:97], v[96:97], v[100:101]
    v_pk_add_f32 v[98:99], v[98:99], v[102:103]
    v_pk_add_f32 v[56:57], v[56:57], v[104:105]
    v_pk_add_f32 v[58:59], v[58:59], v[106:107]
    v_pk_add_f32 v[56:57], v[56:57], v[96:97]
    v_pk_add_f32 v[58:59], v[58:59], v[98:99]
    v_cvt_pk_bf16_f32 v232, v56, v57
    v_cvt_pk_bf16_f32 v233, v58, v59
    ds_write_b64 v10, v[232:233] offset:0
    v_pk_add_f32 v[108:109], v[108:109], v[112:113]
    v_pk_add_f32 v[110:111], v[110:111], v[114:115]
    v_pk_add_f32 v[60:61], v[60:61], v[116:117]
    v_pk_add_f32 v[62:63], v[62:63], v[118:119]
    v_pk_add_f32 v[60:61], v[60:61], v[108:109]
    v_pk_add_f32 v[62:63], v[62:63], v[110:111]
    v_cvt_pk_bf16_f32 v236, v60, v61
    v_cvt_pk_bf16_f32 v237, v62, v63
    ds_write_b64 v10, v[236:237] offset:32
    v_pk_add_f32 v[120:121], v[120:121], v[124:125]
    v_pk_add_f32 v[122:123], v[122:123], v[126:127]
    v_pk_add_f32 v[76:77], v[76:77], v[128:129]
    v_pk_add_f32 v[78:79], v[78:79], v[130:131]
    v_pk_add_f32 v[76:77], v[76:77], v[120:121]
    v_pk_add_f32 v[78:79], v[78:79], v[122:123]
    v_cvt_pk_bf16_f32 v234, v76, v77
    v_cvt_pk_bf16_f32 v235, v78, v79
    ds_write_b64 v10, v[234:235] offset:1024
    v_pk_add_f32 v[132:133], v[132:133], v[136:137]
    v_pk_add_f32 v[134:135], v[134:135], v[138:139]
    v_pk_add_f32 v[80:81], v[80:81], v[140:141]
    v_pk_add_f32 v[82:83], v[82:83], v[142:143]
    v_pk_add_f32 v[80:81], v[80:81], v[132:133]
    v_pk_add_f32 v[82:83], v[82:83], v[134:135]
    v_cvt_pk_bf16_f32 v238, v80, v81
    v_cvt_pk_bf16_f32 v239, v82, v83
    ds_write_b64 v10, v[238:239] offset:1056
    s_waitcnt lgkmcnt(0)
    ds_read_b128 v[204:207], v11 offset:0
    ds_read_b128 v[208:211], v11 offset:1024
    s_waitcnt lgkmcnt(1)
    buffer_store_dwordx4 v[204:207], v12, s[16:19], s44 offen
    s_waitcnt lgkmcnt(0)
    buffer_store_dwordx4 v[208:211], v13, s[16:19], s44 offen
    s_branch DN_done
DN_w2:
    v_mfma_f32_16x16x32_bf16 v[16:19], v[180:183], v[144:147], v[16:19]
    v_mfma_f32_16x16x32_bf16 v[20:23], v[184:187], v[144:147], v[20:23]
    v_mfma_f32_16x16x32_bf16 v[36:39], v[180:183], v[148:151], v[36:39]
    v_mfma_f32_16x16x32_bf16 v[40:43], v[184:187], v[148:151], v[40:43]
    v_mfma_f32_16x16x32_bf16 v[56:59], v[180:183], v[152:155], v[56:59]
    v_mfma_f32_16x16x32_bf16 v[60:63], v[184:187], v[152:155], v[60:63]
    s_nop 2
    ds_write_b128 v2, v[16:19] offset:1024
    v_mfma_f32_16x16x32_bf16 v[64:67], v[188:191], v[152:155], v[64:67]
    s_nop 2
    ds_write_b128 v2, v[20:23] offset:4096
    v_mfma_f32_16x16x32_bf16 v[68:71], v[192:195], v[152:155], v[68:71]
    s_nop 2
    ds_write_b128 v2, v[36:39] offset:16384
    v_mfma_f32_16x16x32_bf16 v[72:75], v[196:199], v[152:155], v[72:75]
    s_nop 2
    ds_write_b128 v2, v[40:43] offset:19456
    v_mfma_f32_16x16x32_bf16 v[76:79], v[180:183], v[156:159], v[76:79]
    s_nop 2
    ds_write_b128 v2, v[56:59] offset:31744
    v_mfma_f32_16x16x32_bf16 v[80:83], v[184:187], v[156:159], v[80:83]
    s_nop 2
    ds_write_b128 v2, v[60:63] offset:34816
    v_mfma_f32_16x16x32_bf16 v[84:87], v[188:191], v[156:159], v[84:87]
    s_nop 2
    ds_write_b128 v2, v[64:67] offset:38912
    v_mfma_f32_16x16x32_bf16 v[88:91], v[192:195], v[156:159], v[88:91]
    s_nop 2
    ds_write_b128 v2, v[68:71] offset:41984
    v_mfma_f32_16x16x32_bf16 v[92:95], v[196:199], v[156:159], v[92:95]
    s_nop 2
    ds_write_b128 v2, v[72:75] offset:45056
    v_mfma_f32_16x16x32_bf16 v[24:27], v[188:191], v[144:147], v[24:27]
    s_nop 2
    ds_write_b128 v2, v[76:79] offset:47104
    v_mfma_f32_16x16x32_bf16 v[28:31], v[192:195], v[144:147], v[28:31]
    s_nop 2
    ds_write_b128 v2, v[80:83] offset:50176
    v_mfma_f32_16x16x32_bf16 v[32:35], v[196:199], v[144:147], v[32:35]
    s_nop 2
    ds_write_b128 v2, v[84:87] offset:54272
    v_mfma_f32_16x16x32_bf16 v[44:47], v[188:191], v[148:151], v[44:47]
    s_nop 2
    ds_write_b128 v2, v[88:91] offset:57344
    v_mfma_f32_16x16x32_bf16 v[48:51], v[192:195], v[148:151], v[48:51]
    s_nop 2
    ds_write_b128 v2, v[92:95] offset:60416
    v_mfma_f32_16x16x32_bf16 v[52:55], v[196:199], v[148:151], v[52:55]
    s_waitcnt lgkmcnt(0)
    s_barrier
    ds_read_b128 v[96:99], v2 offset:6144
    ds_read_b128 v[100:103], v2 offset:7168
    ds_read_b128 v[104:107], v2 offset:8192
    ds_read_b128 v[108:111], v2 offset:9216
    ds_read_b128 v[112:115], v2 offset:10240
    ds_read_b128 v[116:119], v2 offset:11264
    ds_read_b128 v[120:123], v2 offset:12288
    ds_read_b128 v[124:127], v2 offset:13312
    ds_read_b128 v[128:131], v2 offset:14336
    ds_read_b128 v[132:135], v2 offset:21504
    ds_read_b128 v[136:139], v2 offset:22528
    ds_read_b128 v[140:143], v2 offset:23552
    ds_read_b128 v[144:147], v2 offset:24576
    ds_read_b128 v[148:151], v2 offset:25600
    ds_read_b128 v[152:155], v2 offset:26624
    ds_read_b128 v[156:159], v2 offset:27648
    ds_read_b128 v[160:163], v2 offset:28672
    ds_read_b128 v[164:167], v2 offset:29696
    v_lshlrev_b32 v200, 16, v232
    v_and_b32 v201, 0xffff0000, v232
    v_lshlrev_b32 v202, 16, v233
    v_and_b32 v203, 0xffff0000, v233
    v_pk_add_f32 v[24:25], v[24:25], v[200:201]
    v_pk_add_f32 v[26:27], v[26:27], v[202:203]
    v_lshlrev_b32 v200, 16, v236
    v_and_b32 v201, 0xffff0000, v236
    v_lshlrev_b32 v202, 16, v237
    v_and_b32 v203, 0xffff0000, v237
    v_pk_add_f32 v[28:29], v[28:29], v[200:201]
    v_pk_add_f32 v[30:31], v[30:31], v[202:203]
    v_lshlrev_b32 v200, 16, v240
    v_and_b32 v201, 0xffff0000, v240
    v_lshlrev_b32 v202, 16, v241
    v_and_b32 v203, 0xffff0000, v241
    v_pk_add_f32 v[32:33], v[32:33], v[200:201]
    v_pk_add_f32 v[34:35], v[34:35], v[202:203]
    v_lshlrev_b32 v200, 16, v234
    v_and_b32 v201, 0xffff0000, v234
    v_lshlrev_b32 v202, 16, v235
    v_and_b32 v203, 0xffff0000, v235
    v_pk_add_f32 v[44:45], v[44:45], v[200:201]
    v_pk_add_f32 v[46:47], v[46:47], v[202:203]
    v_lshlrev_b32 v200, 16, v238
    v_and_b32 v201, 0xffff0000, v238
    v_lshlrev_b32 v202, 16, v239
    v_and_b32 v203, 0xffff0000, v239
    v_pk_add_f32 v[48:49], v[48:49], v[200:201]
    v_pk_add_f32 v[50:51], v[50:51], v[202:203]
    v_lshlrev_b32 v200, 16, v242
    v_and_b32 v201, 0xffff0000, v242
    v_lshlrev_b32 v202, 16, v243
    v_and_b32 v203, 0xffff0000, v243
    v_pk_add_f32 v[52:53], v[52:53], v[200:201]
    v_pk_add_f32 v[54:55], v[54:55], v[202:203]
    s_waitcnt lgkmcnt(0)
    v_pk_add_f32 v[96:97], v[96:97], v[100:101]
    v_pk_add_f32 v[98:99], v[98:99], v[102:103]
    v_pk_add_f32 v[24:25], v[24:25], v[104:105]
    v_pk_add_f32 v[26:27], v[26:27], v[106:107]
    v_pk_add_f32 v[24:25], v[24:25], v[96:97]
    v_pk_add_f32 v[26:27], v[26:27], v[98:99]
    v_cvt_pk_bf16_f32 v232, v24, v25
    v_cvt_pk_bf16_f32 v233, v26, v27
    ds_write_b64 v10, v[232:233] offset:0
    v_pk_add_f32 v[108:109], v[108:109], v[112:113]
    v_pk_add_f32 v[110:111], v[110:111], v[114:115]
    v_pk_add_f32 v[28:29], v[28:29], v[116:117]
    v_pk_add_f32 v[30:31], v[30:31], v[118:119]
    v_pk_add_f32 v[28:29], v[28:29], v[108:109]
    v_pk_add_f32 v[30:31], v[30:31], v[110:111]
    v_cvt_pk_bf16_f32 v236, v28, v29
    v_cvt_pk_bf16_f32 v237, v30, v31
    ds_write_b64 v10, v[236:237] offset:32
    v_pk_add_f32 v[120:121], v[120:121], v[124:125]
    v_pk_add_f32 v[122:123], v[122:123], v[126:127]
    v_pk_add_f32 v[32:33], v[32:33], v[128:129]
    v_pk_add_f32 v[34:35], v[34:35], v[130:131]
    v_pk_add_f32 v[32:33], v[32:33], v[120:121]
    v_pk_add_f32 v[34:35], v[34:35], v[122:123]
    v_cvt_pk_bf16_f32 v240, v32, v33
    v_cvt_pk_bf16_f32 v241, v34, v35
    ds_write_b64 v10, v[240:241] offset:64
    v_pk_add_f32 v[132:133], v[132:133], v[136:137]
    v_pk_add_f32 v[134:135], v[134:135], v[138:139]
    v_pk_add_f32 v[44:45], v[44:45], v[140:141]
    v_pk_add_f32 v[46:47], v[46:47], v[142:143]
    v_pk_add_f32 v[44:45], v[44:45], v[132:133]
    v_pk_add_f32 v[46:47], v[46:47], v[134:135]
    v_cvt_pk_bf16_f32 v234, v44, v45
    v_cvt_pk_bf16_f32 v235, v46, v47
    ds_write_b64 v10, v[234:235] offset:1536
    v_pk_add_f32 v[144:145], v[144:145], v[148:149]
    v_pk_add_f32 v[146:147], v[146:147], v[150:151]
    v_pk_add_f32 v[48:49], v[48:49], v[152:153]
    v_pk_add_f32 v[50:51], v[50:51], v[154:155]
    v_pk_add_f32 v[48:49], v[48:49], v[144:145]
    v_pk_add_f32 v[50:51], v[50:51], v[146:147]
    v_cvt_pk_bf16_f32 v238, v48, v49
    v_cvt_pk_bf16_f32 v239, v50, v51
    ds_write_b64 v10, v[238:239] offset:1568
    v_pk_add_f32 v[156:157], v[156:157], v[160:161]
    v_pk_add_f32 v[158:159], v[158:159], v[162:163]
    v_pk_add_f32 v[52:53], v[52:53], v[164:165]
    v_pk_add_f32 v[54:55], v[54:55], v[166:167]
    v_pk_add_f32 v[52:53], v[52:53], v[156:157]
    v_pk_add_f32 v[54:55], v[54:55], v[158:159]
    v_cvt_pk_bf16_f32 v242, v52, v53
    v_cvt_pk_bf16_f32 v243, v54, v55
    ds_write_b64 v10, v[242:243] offset:1600
    s_waitcnt lgkmcnt(0)
    ds_read_b128 v[204:207], v11 offset:0
    ds_read_b128 v[208:211], v11 offset:1024
    ds_read_b128 v[212:215], v11 offset:2048
    s_waitcnt lgkmcnt(2)
    buffer_store_dwordx4 v[204:207], v12, s[16:19], s44 offen
    s_waitcnt lgkmcnt(1)
    buffer_store_dwordx4 v[208:211], v13, s[16:19], s44 offen
    s_waitcnt lgkmcnt(0)
    buffer_store_dwordx4 v[212:215], v14, s[16:19], s44 offen
    s_branch DN_done
DN_w3:
    v_mfma_f32_16x16x32_bf16 v[16:19], v[180:183], v[144:147], v[16:19]
    v_mfma_f32_16x16x32_bf16 v[20:23], v[184:187], v[144:147], v[20:23]
    v_mfma_f32_16x16x32_bf16 v[24:27], v[188:191], v[144:147], v[24:27]
    v_mfma_f32_16x16x32_bf16 v[28:31], v[192:195], v[144:147], v[28:31]
    v_mfma_f32_16x16x32_bf16 v[32:35], v[196:199], v[144:147], v[32:35]
    v_mfma_f32_16x16x32_bf16 v[36:39], v[180:183], v[148:151], v[36:39]
    s_nop 2
    ds_write_b128 v2, v[16:19] offset:2048
    v_mfma_f32_16x16x32_bf16 v[40:43], v[184:187], v[148:151], v[40:43]
    s_nop 2
    ds_write_b128 v2, v[20:23] offset:5120
    v_mfma_f32_16x16x32_bf16 v[44:47], v[188:191], v[148:151], v[44:47]
    s_nop 2
    ds_write_b128 v2, v[24:27] offset:8192
    v_mfma_f32_16x16x32_bf16 v[48:51], v[192:195], v[148:151], v[48:51]
    s_nop 2
    ds_write_b128 v2, v[28:31] offset:11264
    v_mfma_f32_16x16x32_bf16 v[52:55], v[196:199], v[148:151], v[52:55]
    s_nop 2
    ds_write_b128 v2, v[32:35] offset:14336
    v_mfma_f32_16x16x32_bf16 v[56:59], v[180:183], v[152:155], v[56:59]
    s_nop 2
    ds_write_b128 v2, v[36:39] offset:17408
    v_mfma_f32_16x16x32_bf16 v[60:63], v[184:187], v[152:155], v[60:63]
    s_nop 2
    ds_write_b128 v2, v[40:43] offset:20480
    v_mfma_f32_16x16x32_bf16 v[76:79], v[180:183], v[156:159], v[76:79]
    s_nop 2
    ds_write_b128 v2, v[44:47] offset:23552
    v_mfma_f32_16x16x32_bf16 v[80:83], v[184:187], v[156:159], v[80:83]
    s_nop 2
    ds_write_b128 v2, v[48:51] offset:26624
    v_mfma_f32_16x16x32_bf16 v[64:67], v[188:191], v[152:155], v[64:67]
    s_nop 2
    ds_write_b128 v2, v[52:55] offset:29696
    v_mfma_f32_16x16x32_bf16 v[68:71], v[192:195], v[152:155], v[68:71]
    s_nop 2
    ds_write_b128 v2, v[56:59] offset:32768
    v_mfma_f32_16x16x32_bf16 v[72:75], v[196:199], v[152:155], v[72:75]
    s_nop 2
    ds_write_b128 v2, v[60:63] offset:35840
    v_mfma_f32_16x16x32_bf16 v[84:87], v[188:191], v[156:159], v[84:87]
    s_nop 2
    ds_write_b128 v2, v[76:79] offset:48128
    v_mfma_f32_16x16x32_bf16 v[88:91], v[192:195], v[156:159], v[88:91]
    s_nop 2
    ds_write_b128 v2, v[80:83] offset:51200
    v_mfma_f32_16x16x32_bf16 v[92:95], v[196:199], v[156:159], v[92:95]
    s_waitcnt lgkmcnt(0)
    s_barrier
    ds_read_b128 v[96:99], v2 offset:36864
    ds_read_b128 v[100:103], v2 offset:37888
    ds_read_b128 v[104:107], v2 offset:38912
    ds_read_b128 v[108:111], v2 offset:39936
    ds_read_b128 v[112:115], v2 offset:40960
    ds_read_b128 v[116:119], v2 offset:41984
    ds_read_b128 v[120:123], v2 offset:43008
    ds_read_b128 v[124:127], v2 offset:44032
    ds_read_b128 v[128:131], v2 offset:45056
    ds_read_b128 v[132:135], v2 offset:52224
    ds_read_b128 v[136:139], v2 offset:53248
    ds_read_b128 v[140:143], v2 offset:54272
    ds_read_b128 v[144:147], v2 offset:55296
    ds_read_b128 v[148:151], v2 offset:56320
    ds_read_b128 v[152:155], v2 offset:57344
    ds_read_b128 v[156:159], v2 offset:58368
    ds_read_b128 v[160:163], v2 offset:59392
    ds_read_b128 v[164:167], v2 offset:60416
    v_lshlrev_b32 v200, 16, v232
    v_and_b32 v201, 0xffff0000, v232
    v_lshlrev_b32 v202, 16, v233
    v_and_b32 v203, 0xffff0000, v233
    v_pk_add_f32 v[64:65], v[64:65], v[200:201]
    v_pk_add_f32 v[66:67], v[66:67], v[202:203]
    v_lshlrev_b32 v200, 16, v236
    v_and_b32 v201, 0xffff0000, v236
    v_lshlrev_b32 v202, 16, v237
    v_and_b32 v203, 0xffff0000, v237
    v_pk_add_f32 v[68:69], v[68:69], v[200:201]
    v_pk_add_f32 v[70:71], v[70:71], v[202:203]
    v_lshlrev_b32 v200, 16, v240
    v_and_b32 v201, 0xffff0000, v240
    v_lshlrev_b32 v202, 16, v241
    v_and_b32 v203, 0xffff0000, v241
    v_pk_add_f32 v[72:73], v[72:73], v[200:201]
    v_pk_add_f32 v[74:75], v[74:75], v[202:203]
    v_lshlrev_b32 v200, 16, v234
    v_and_b32 v201, 0xffff0000, v234
    v_lshlrev_b32 v202, 16, v235
    v_and_b32 v203, 0xffff0000, v235
    v_pk_add_f32 v[84:85], v[84:85], v[200:201]
    v_pk_add_f32 v[86:87], v[86:87], v[202:203]
    v_lshlrev_b32 v200, 16, v238
    v_and_b32 v201, 0xffff0000, v238
    v_lshlrev_b32 v202, 16, v239
    v_and_b32 v203, 0xffff0000, v239
    v_pk_add_f32 v[88:89], v[88:89], v[200:201]
    v_pk_add_f32 v[90:91], v[90:91], v[202:203]
    v_lshlrev_b32 v200, 16, v242
    v_and_b32 v201, 0xffff0000, v242
    v_lshlrev_b32 v202, 16, v243
    v_and_b32 v203, 0xffff0000, v243
    v_pk_add_f32 v[92:93], v[92:93], v[200:201]
    v_pk_add_f32 v[94:95], v[94:95], v[202:203]
    s_waitcnt lgkmcnt(0)
    v_pk_add_f32 v[96:97], v[96:97], v[100:101]
    v_pk_add_f32 v[98:99], v[98:99], v[102:103]
    v_pk_add_f32 v[64:65], v[64:65], v[104:105]
    v_pk_add_f32 v[66:67], v[66:67], v[106:107]
    v_pk_add_f32 v[64:65], v[64:65], v[96:97]
    v_pk_add_f32 v[66:67], v[66:67], v[98:99]
    v_cvt_pk_bf16_f32 v232, v64, v65
    v_cvt_pk_bf16_f32 v233, v66, v67
    ds_write_b64 v10, v[232:233] offset:0
    v_pk_add_f32 v[108:109], v[108:109], v[112:113]
    v_pk_add_f32 v[110:111], v[110:111], v[114:115]
    v_pk_add_f32 v[68:69], v[68:69], v[116:117]
    v_pk_add_f32 v[70:71], v[70:71], v[118:119]
    v_pk_add_f32 v[68:69], v[68:69], v[108:109]
    v_pk_add_f32 v[70:71], v[70:71], v[110:111]
    v_cvt_pk_bf16_f32 v236, v68, v69
    v_cvt_pk_bf16_f32 v237, v70, v71
    ds_write_b64 v10, v[236:237] offset:32
    v_pk_add_f32 v[120:121], v[120:121], v[124:125]
    v_pk_add_f32 v[122:123], v[122:123], v[126:127]
    v_pk_add_f32 v[72:73], v[72:73], v[128:129]
    v_pk_add_f32 v[74:75], v[74:75], v[130:131]
    v_pk_add_f32 v[72:73], v[72:73], v[120:121]
    v_pk_add_f32 v[74:75], v[74:75], v[122:123]
    v_cvt_pk_bf16_f32 v240, v72, v73
    v_cvt_pk_bf16_f32 v241, v74, v75
    ds_write_b64 v10, v[240:241] offset:64
    v_pk_add_f32 v[132:133], v[132:133], v[136:137]
    v_pk_add_f32 v[134:135], v[134:135], v[138:139]
    v_pk_add_f32 v[84:85], v[84:85], v[140:141]
    v_pk_add_f32 v[86:87], v[86:87], v[142:143]
    v_pk_add_f32 v[84:85], v[84:85], v[132:133]
    v_pk_add_f32 v[86:87], v[86:87], v[134:135]
    v_cvt_pk_bf16_f32 v234, v84, v85
    v_cvt_pk_bf16_f32 v235, v86, v87
    ds_write_b64 v10, v[234:235] offset:1536
    v_pk_add_f32 v[144:145], v[144:145], v[148:149]
    v_pk_add_f32 v[146:147], v[146:147], v[150:151]
    v_pk_add_f32 v[88:89], v[88:89], v[152:153]
    v_pk_add_f32 v[90:91], v[90:91], v[154:155]
    v_pk_add_f32 v[88:89], v[88:89], v[144:145]
    v_pk_add_f32 v[90:91], v[90:91], v[146:147]
    v_cvt_pk_bf16_f32 v238, v88, v89
    v_cvt_pk_bf16_f32 v239, v90, v91
    ds_write_b64 v10, v[238:239] offset:1568
    v_pk_add_f32 v[156:157], v[156:157], v[160:161]
    v_pk_add_f32 v[158:159], v[158:159], v[162:163]
    v_pk_add_f32 v[92:93], v[92:93], v[164:165]
    v_pk_add_f32 v[94:95], v[94:95], v[166:167]
    v_pk_add_f32 v[92:93], v[92:93], v[156:157]
    v_pk_add_f32 v[94:95], v[94:95], v[158:159]
    v_cvt_pk_bf16_f32 v242, v92, v93
    v_cvt_pk_bf16_f32 v243, v94, v95
    ds_write_b64 v10, v[242:243] offset:1600
    s_waitcnt lgkmcnt(0)
    ds_read_b128 v[204:207], v11 offset:0
    ds_read_b128 v[208:211], v11 offset:1024
    ds_read_b128 v[212:215], v11 offset:2048
    s_waitcnt lgkmcnt(2)
    buffer_store_dwordx4 v[204:207], v12, s[16:19], s44 offen
    s_waitcnt lgkmcnt(1)
    buffer_store_dwordx4 v[208:211], v13, s[16:19], s44 offen
    s_waitcnt lgkmcnt(0)
    buffer_store_dwordx4 v[212:215], v14, s[16:19], s44 offen
DN_done:
K2_fin:
    s_endpgm
K2_slow:
    s_mov_b32 s35, 1
    s_waitcnt vmcnt(0) lgkmcnt(0)
    s_mul_i32 s10, s29, 320
    v_lshl_add_u32 v5, v31, 4, s10
    v_mov_b32 v26, 10240
    v_cmp_gt_u32 vcc, 20, v1
    v_mul_u32_u24 v27, 10368, v7
    v_mov_b32 v31, 0x40000000
    v_cndmask_b32 v5, v26, v5, vcc
    v_cmp_gt_u32 vcc, 21, v1
    v_add_u32 v5, v5, v27
    s_mov_b32 s32, s31
    v_cndmask_b32 v5, v31, v5, vcc
    v_add_u32 v6, 20736, v5
    s_mov_b32 s34, 0
K2_smax:
    buffer_load_dwordx4 v[144:147], v2, s[24:27], s32 offen offset:0
    buffer_load_dwordx2 v[148:149], v4, s[24:27], s32 offen offset:0
    s_waitcnt vmcnt(0)
    v_mfma_f32_32x32x16_bf16 v[64:79], v[144:147], v[8:11], 0
    v_mfma_f32_32x32x8_bf16 v[64:79], v[148:149], v[12:13], v[64:79]
    v_mfma_f32_32x32x16_bf16 v[80:95], v[144:147], v[16:19], 0
    v_mfma_f32_32x32x8_bf16 v[80:95], v[148:149], v[20:21], v[80:95]
    s_nop 11
    v_max3_f32 v24, v64, v65, v24
    v_max3_f32 v24, v66, v67, v24
    v_max3_f32 v24, v68, v69, v24
    v_max3_f32 v24, v70, v71, v24
    v_max3_f32 v24, v72, v73, v24
    v_max3_f32 v24, v74, v75, v24
    v_max3_f32 v24, v76, v77, v24
    v_max3_f32 v24, v78, v79, v24
    v_max3_f32 v25, v80, v81, v25
    v_max3_f32 v25, v82, v83, v25
    v_max3_f32 v25, v84, v85, v25
    v_max3_f32 v25, v86, v87, v25
    v_max3_f32 v25, v88, v89, v25
    v_max3_f32 v25, v90, v91, v25
    v_max3_f32 v25, v92, v93, v25
    v_max3_f32 v25, v94, v95, v25
    s_add_u32 s32, s32, 512
    s_add_u32 s34, s34, 1
    s_cmp_lt_u32 s34, 64
    s_cbranch_scc1 K2_smax
    v_mov_b32 v26, v24
    s_nop 1
    v_permlane32_swap_b32 v24, v26
    s_nop 1
    v_max_f32 v24, v24, v26
    v_sub_f32 v32, 0, v24
    v_sub_f32 v33, 0, v24
    v_sub_f32 v34, 0, v24
    v_sub_f32 v35, 0, v24
    v_sub_f32 v36, 0, v24
    v_sub_f32 v37, 0, v24
    v_sub_f32 v38, 0, v24
    v_sub_f32 v39, 0, v24
    v_sub_f32 v40, 0, v24
    v_sub_f32 v41, 0, v24
    v_sub_f32 v42, 0, v24
    v_sub_f32 v43, 0, v24
    v_sub_f32 v44, 0, v24
    v_sub_f32 v45, 0, v24
    v_sub_f32 v46, 0, v24
    v_sub_f32 v47, 0, v24
    v_mov_b32 v26, v25
    s_nop 1
    v_permlane32_swap_b32 v25, v26
    s_nop 1
    v_max_f32 v25, v25, v26
    v_sub_f32 v48, 0, v25
    v_sub_f32 v49, 0, v25
    v_sub_f32 v50, 0, v25
    v_sub_f32 v51, 0, v25
    v_sub_f32 v52, 0, v25
    v_sub_f32 v53, 0, v25
    v_sub_f32 v54, 0, v25
    v_sub_f32 v55, 0, v25
    v_sub_f32 v56, 0, v25
    v_sub_f32 v57, 0, v25
    v_sub_f32 v58, 0, v25
    v_sub_f32 v59, 0, v25
    v_sub_f32 v60, 0, v25
    v_sub_f32 v61, 0, v25
    v_sub_f32 v62, 0, v25
    v_sub_f32 v63, 0, v25
    v_mov_b32 v112, 0
    v_mov_b32 v113, 0
    v_mov_b32 v114, 0
    v_mov_b32 v115, 0
    v_mov_b32 v116, 0
    v_mov_b32 v117, 0
    v_mov_b32 v118, 0
    v_mov_b32 v119, 0
    v_mov_b32 v120, 0
    v_mov_b32 v121, 0
    v_mov_b32 v122, 0
    v_mov_b32 v123, 0
    v_mov_b32 v124, 0
    v_mov_b32 v125, 0
    v_mov_b32 v126, 0
    v_mov_b32 v127, 0
    v_mov_b32 v128, 0
    v_mov_b32 v129, 0
    v_mov_b32 v130, 0
    v_mov_b32 v131, 0
    v_mov_b32 v132, 0
    v_mov_b32 v133, 0
    v_mov_b32 v134, 0
    v_mov_b32 v135, 0
    v_mov_b32 v136, 0
    v_mov_b32 v137, 0
    v_mov_b32 v138, 0
    v_mov_b32 v139, 0
    v_mov_b32 v140, 0
    v_mov_b32 v141, 0
    v_mov_b32 v142, 0
    v_mov_b32 v143, 0
    s_mov_b32 s32, s31
    s_mov_b32 s33, 5242880
    s_mov_b32 s34, 0
K2_sloop:
    buffer_load_dwordx4 v[144:147], v2, s[24:27], s32 offen offset:0
    buffer_load_dwordx2 v[148:149], v4, s[24:27], s32 offen offset:0
    buffer_load_dwordx4 v[152:155], v5, s[24:27], s33 offen
    buffer_load_dwordx4 v[156:159], v6, s[24:27], s33 offen
    s_waitcnt vmcnt(0)
    v_mfma_f32_32x32x16_bf16 v[64:79], v[144:147], v[8:11], v[32:47]
    v_mfma_f32_32x32x8_bf16 v[64:79], v[148:149], v[12:13], v[64:79]
    v_mfma_f32_32x32x16_bf16 v[80:95], v[144:147], v[16:19], v[48:63]
    v_mfma_f32_32x32x8_bf16 v[80:95], v[148:149], v[20:21], v[80:95]
    s_nop 11
    v_exp_f32 v64, v64
    v_exp_f32 v65, v65
    v_exp_f32 v66, v66
    v_exp_f32 v67, v67
    v_exp_f32 v68, v68
    v_exp_f32 v69, v69
    v_exp_f32 v70, v70
    v_exp_f32 v71, v71
    v_exp_f32 v72, v72
    v_exp_f32 v73, v73
    v_exp_f32 v74, v74
    v_exp_f32 v75, v75
    v_exp_f32 v76, v76
    v_exp_f32 v77, v77
    v_exp_f32 v78, v78
    v_exp_f32 v79, v79
    v_exp_f32 v80, v80
    v_exp_f32 v81, v81
    v_exp_f32 v82, v82
    v_exp_f32 v83, v83
    v_exp_f32 v84, v84
    v_exp_f32 v85, v85
    v_exp_f32 v86, v86
    v_exp_f32 v87, v87
    v_exp_f32 v88, v88
    v_exp_f32 v89, v89
    v_exp_f32 v90, v90
    v_exp_f32 v91, v91
    v_exp_f32 v92, v92
    v_exp_f32 v93, v93
    v_exp_f32 v94, v94
    v_exp_f32 v95, v95
    s_nop 0
    v_cvt_pk_bf16_f32 v96, v64, v65
    v_cvt_pk_bf16_f32 v97, v66, v67
    v_cvt_pk_bf16_f32 v98, v68, v69
    v_cvt_pk_bf16_f32 v99, v70, v71
    v_cvt_pk_bf16_f32 v100, v72, v73
    v_cvt_pk_bf16_f32 v101, v74, v75
    v_cvt_pk_bf16_f32 v102, v76, v77
    v_cvt_pk_bf16_f32 v103, v78, v79
    v_cvt_pk_bf16_f32 v104, v80, v81
    v_cvt_pk_bf16_f32 v105, v82, v83
    v_cvt_pk_bf16_f32 v106, v84, v85
    v_cvt_pk_bf16_f32 v107, v86, v87
    v_cvt_pk_bf16_f32 v108, v88, v89
    v_cvt_pk_bf16_f32 v109, v90, v91
    v_cvt_pk_bf16_f32 v110, v92, v93
    v_cvt_pk_bf16_f32 v111, v94, v95
    s_nop 1
    v_mfma_f32_32x32x16_bf16 v[112:127], v[152:155], v[96:99], v[112:127]
    v_mfma_f32_32x32x16_bf16 v[128:143], v[152:155], v[104:107], v[128:143]
    v_mfma_f32_32x32x16_bf16 v[112:127], v[156:159], v[100:103], v[112:127]
    v_mfma_f32_32x32x16_bf16 v[128:143], v[156:159], v[108:111], v[128:143]
    s_add_u32 s32, s32, 512
    s_add_u32 s33, s33, 41472
    s_add_u32 s34, s34, 1
    s_cmp_lt_u32 s34, 64
    s_cbranch_scc1 K2_sloop
    s_nop 15
    s_branch K2_out
K2_service:
    v_lshlrev_b32 v12, 4, v1
    v_lshl_add_u32 v12, v7, 15, v12
    v_lshlrev_b32 v13, 4, v1
    v_mul_u32_u24 v14, 65024, v7
    v_sub_u32 v13, v13, v14
    v_add_u32 v13, 65536, v13
    v_add_u32 v14, 33280, v12
    s_mul_i32 s10, s29, 320
    v_mov_b32 v10, 10240
    v_mov_b32 v11, 0x40000000
    v_add_u32 v1, 0, v0
    v_mul_u32_u24 v2, 2731, v1
    v_lshrrev_b32 v2, 16, v2
    v_mul_u32_u24 v8, 24, v2
    v_sub_u32 v8, v1, v8
    v_lshl_add_u32 v9, v8, 4, s10
    v_cmp_gt_u32 vcc, 20, v8
    v_mul_u32_u24 v2, 10368, v2
    s_nop 0
    v_cndmask_b32 v9, v10, v9, vcc
    v_cmp_gt_u32 vcc, 21, v8
    v_add_u32 v9, v9, v2
    s_nop 0
    v_cndmask_b32 v5, v11, v9, vcc
    v_add_u32 v1, 64, v0
    v_mul_u32_u24 v2, 2731, v1
    v_lshrrev_b32 v2, 16, v2
    v_mul_u32_u24 v8, 24, v2
    v_sub_u32 v8, v1, v8
    v_lshl_add_u32 v9, v8, 4, s10
    v_cmp_gt_u32 vcc, 20, v8
    v_mul_u32_u24 v2, 10368, v2
    s_nop 0
    v_cndmask_b32 v9, v10, v9, vcc
    v_cmp_gt_u32 vcc, 21, v8
    v_add_u32 v9, v9, v2
    s_nop 0
    v_cndmask_b32 v6, v11, v9, vcc
    v_add_u32 v1, 128, v0
    v_mul_u32_u24 v2, 2731, v1
    v_lshrrev_b32 v2, 16, v2
    v_mul_u32_u24 v8, 24, v2
    v_sub_u32 v8, v1, v8
    v_lshl_add_u32 v9, v8, 4, s10
    v_cmp_gt_u32 vcc, 20, v8
    v_mul_u32_u24 v2, 10368, v2
    s_nop 0
    v_cndmask_b32 v9, v10, v9, vcc
    v_cmp_gt_u32 vcc, 21, v8
    v_add_u32 v9, v9, v2
    s_nop 0
    v_cndmask_b32 v7, v11, v9, vcc
    s_add_u32 s32, s31, 512
    s_mov_b32 s33, 5242880
    s_mov_b32 s34, 0
    s_and_b32 s11, s28, 3
    s_mul_i32 s10, s11, 82944
    s_add_u32 s36, s33, s10
    s_lshl_b32 s10, s11, 10
    s_add_u32 s37, s32, s10
    s_mul_i32 s35, s11, 3072
    s_waitcnt lgkmcnt(0)
    s_mov_b32 s24, s8
    s_and_b32 s25, s9, 0xffff
    s_mov_b32 s26, 34603008
    s_mov_b32 s27, 0x00020000
    s_add_u32 m0, s35, 0
    s_nop 0
    buffer_load_dwordx4 v12, s[24:27], s37 offen lds
    s_add_u32 m0, s35, 12288
    s_nop 0
    buffer_load_dwordx4 v5, s[24:27], s36 offen lds
    s_add_u32 m0, s35, 1024
    s_nop 0
    buffer_load_dwordx4 v13, s[24:27], s37 offen lds
    s_add_u32 m0, s35, 13312
    s_nop 0
    buffer_load_dwordx4 v6, s[24:27], s36 offen lds
    s_add_u32 m0, s35, 2048
    s_nop 0
    buffer_load_dwordx4 v14, s[24:27], s37 offen lds
    s_add_u32 m0, s35, 14336
    s_nop 0
    buffer_load_dwordx4 v7, s[24:27], s36 offen lds
    s_cmp_gt_u32 s28, 4
    s_cbranch_scc1 K2_helper
    v_lshlrev_b32 v15, 4, v0
    v_add_u32 v180, 5760, v15
    v_cmp_gt_u32 vcc, 24, v0
    s_mov_b32 s35, 1
    s_nop 0
    v_cndmask_b32 v180, v180, v15, vcc
    v_lshlrev_b32 v20, 7, v0
    v_and_b32 v21, 31, v0
    v_lshlrev_b32 v21, 7, v21
    v_lshrrev_b32 v22, 5, v0
    v_mul_u32_u24 v22, 188416, v22
    v_add3_u32 v21, v21, v22, 0
    v_add_u32 v21, 8192, v21
    v_add_u32 v22, 200704, v20
    s_add_u32 s32, s32, 4096
    s_add_u32 s33, s33, 331776
    s_mov_b32 s34, 24576
K2_kv0:
    s_add_u32 m0, s34, 12288
    s_nop 0
    buffer_load_dwordx4 v5, s[24:27], s33 offen lds
    s_add_u32 m0, s34, 0
    s_nop 0
    buffer_load_dwordx4 v12, s[24:27], s32 offen offset:0 lds
    s_add_u32 m0, s34, 13312
    s_nop 0
    buffer_load_dwordx4 v6, s[24:27], s33 offen lds
    s_add_u32 m0, s34, 1024
    s_nop 0
    buffer_load_dwordx4 v13, s[24:27], s32 offen offset:0 lds
    s_add_u32 m0, s34, 14336
    s_nop 0
    buffer_load_dwordx4 v7, s[24:27], s33 offen lds
    s_add_u32 m0, s34, 2048
    s_nop 0
    buffer_load_dwordx4 v14, s[24:27], s32 offen offset:0 lds
    s_add_u32 s33, s33, 82944
    s_add_u32 m0, s34, 15360
    s_nop 0
    buffer_load_dwordx4 v5, s[24:27], s33 offen lds
    s_add_u32 m0, s34, 2048
    s_nop 0
    buffer_load_dwordx4 v12, s[24:27], s32 offen offset:1024 lds
    s_add_u32 m0, s34, 16384
    s_nop 0
    buffer_load_dwordx4 v6, s[24:27], s33 offen lds
    s_add_u32 m0, s34, 3072
    s_nop 0
    buffer_load_dwordx4 v13, s[24:27], s32 offen offset:1024 lds
    s_add_u32 m0, s34, 17408
    s_nop 0
    buffer_load_dwordx4 v7, s[24:27], s33 offen lds
    s_add_u32 m0, s34, 4096
    s_nop 0
    buffer_load_dwordx4 v14, s[24:27], s32 offen offset:1024 lds
    s_add_u32 s33, s33, 82944
    s_add_u32 m0, s34, 18432
    s_nop 0
    buffer_load_dwordx4 v5, s[24:27], s33 offen lds
    s_add_u32 m0, s34, 4096
    s_nop 0
    buffer_load_dwordx4 v12, s[24:27], s32 offen offset:2048 lds
    s_add_u32 m0, s34, 19456
    s_nop 0
    buffer_load_dwordx4 v6, s[24:27], s33 offen lds
    s_add_u32 m0, s34, 5120
    s_nop 0
    buffer_load_dwordx4 v13, s[24:27], s32 offen offset:2048 lds
    s_add_u32 m0, s34, 20480
    s_nop 0
    buffer_load_dwordx4 v7, s[24:27], s33 offen lds
    s_add_u32 m0, s34, 6144
    s_nop 0
    buffer_load_dwordx4 v14, s[24:27], s32 offen offset:2048 lds
    s_add_u32 s33, s33, 82944
    s_add_u32 m0, s34, 21504
    s_nop 0
    buffer_load_dwordx4 v5, s[24:27], s33 offen lds
    s_add_u32 m0, s34, 6144
    s_nop 0
    buffer_load_dwordx4 v12, s[24:27], s32 offen offset:3072 lds
    s_add_u32 m0, s34, 22528
    s_nop 0
    buffer_load_dwordx4 v6, s[24:27], s33 offen lds
    s_add_u32 m0, s34, 7168
    s_nop 0
    buffer_load_dwordx4 v13, s[24:27], s32 offen offset:3072 lds
    s_add_u32 m0, s34, 23552
    s_nop 0
    buffer_load_dwordx4 v7, s[24:27], s33 offen lds
    s_add_u32 m0, s34, 8192
    s_nop 0
    buffer_load_dwordx4 v14, s[24:27], s32 offen offset:3072 lds
    s_add_u32 s33, s33, 82944
    s_add_u32 s32, s32, 4096
    s_add_u32 s34, s34, 24576
    s_cmp_eq_u32 s34, 73728
    s_cselect_b32 s34, 0, s34
    s_cmp_eq_u32 s35, 7
    s_cbranch_scc1 K2_kvA
    s_add_u32 s35, s35, 1
    s_waitcnt vmcnt(24)
    s_barrier
    s_branch K2_kv0
K2_kvA:
    s_setprio 3
    v_lshlrev_b32 v1, 8, v0
    s_mov_b32 s10, 27090944
    s_mov_b32 s11, 0
    s_mov_b64 exec, 0xff
PW4_poll:
    buffer_load_dword v2, v1, s[24:27], s10 offen sc1
    s_add_u32 s11, s11, 1
    s_waitcnt vmcnt(0)
    v_cmp_gt_u32 vcc, 32, v2
    s_nop 0
    s_cmp_eq_u64 vcc, 0
    s_cbranch_scc1 PW4_got
    s_sleep 8
    s_cmp_lt_u32 s11, 0x4000
    s_cbranch_scc1 PW4_poll
PW4_got:
    s_mov_b64 exec, -1
    s_setprio 0
    s_and_b32 s11, s28, 1
    s_and_b32 s48, s28, 3
    s_mul_i32 s58, s55, 6144
    s_mul_i32 s10, s48, 98304
    s_add_u32 s58, s58, s10
    s_add_u32 s58, s58, 20316160
    s_mul_i32 s59, s57, 5120
    s_mul_i32 s10, s11, 40960
    s_add_u32 s59, s59, s10
    s_lshr_b32 s10, s48, 1
    s_mul_i32 s10, s10, 491520
    s_add_u32 s59, s59, s10
    s_add_u32 s59, s59, 24739840
    s_add_u32 s10, s58, 4096
    buffer_load_dwordx4 v[184:187], v15, s[24:27], s58 offen offset:0 sc1
    buffer_load_dwordx4 v[188:191], v15, s[24:27], s58 offen offset:1024 sc1
    buffer_load_dwordx4 v[192:195], v15, s[24:27], s58 offen offset:2048 sc1
    buffer_load_dwordx4 v[196:199], v15, s[24:27], s58 offen offset:3072 sc1
    buffer_load_dwordx4 v[200:203], v15, s[24:27], s10 offen offset:0 sc1
    buffer_load_dwordx4 v[204:207], v15, s[24:27], s10 offen offset:1024 sc1
    s_add_u32 s58, s58, 393216
    s_add_u32 s10, s58, 4096
    buffer_load_dwordx4 v[208:211], v15, s[24:27], s58 offen offset:0 sc1
    buffer_load_dwordx4 v[212:215], v15, s[24:27], s58 offen offset:1024 sc1
    buffer_load_dwordx4 v[216:219], v15, s[24:27], s58 offen offset:2048 sc1
    buffer_load_dwordx4 v[220:223], v15, s[24:27], s58 offen offset:3072 sc1
    buffer_load_dwordx4 v[224:227], v15, s[24:27], s10 offen offset:0 sc1
    buffer_load_dwordx4 v[228:231], v15, s[24:27], s10 offen offset:1024 sc1
    s_add_u32 s58, s58, 393216
    s_add_u32 s10, s58, 4096
    buffer_load_dwordx4 v[232:235], v15, s[24:27], s58 offen offset:0 sc1
    buffer_load_dwordx4 v[236:239], v15, s[24:27], s58 offen offset:1024 sc1
    buffer_load_dwordx4 v[240:243], v15, s[24:27], s58 offen offset:2048 sc1
    buffer_load_dwordx4 v[244:247], v15, s[24:27], s58 offen offset:3072 sc1
    buffer_load_dwordx4 v[248:251], v15, s[24:27], s10 offen offset:0 sc1
    buffer_load_dwordx4 v[252:255], v15, s[24:27], s10 offen offset:1024 sc1
    s_add_u32 s58, s58, 393216
    s_barrier
    s_add_u32 s10, s59, 4096
    buffer_load_dwordx4 v[16:19], v15, s[24:27], s59 offen offset:0 sc1
    buffer_load_dwordx4 v[20:23], v15, s[24:27], s59 offen offset:1024 sc1
    buffer_load_dwordx4 v[24:27], v15, s[24:27], s59 offen offset:2048 sc1
    buffer_load_dwordx4 v[28:31], v15, s[24:27], s59 offen offset:3072 sc1
    buffer_load_dwordx4 v[32:35], v15, s[24:27], s10 offen offset:0 sc1
    s_add_u32 s59, s59, 81920
    s_add_u32 s10, s59, 4096
    buffer_load_dwordx4 v[36:39], v15, s[24:27], s59 offen offset:0 sc1
    buffer_load_dwordx4 v[40:43], v15, s[24:27], s59 offen offset:1024 sc1
    buffer_load_dwordx4 v[44:47], v15, s[24:27], s59 offen offset:2048 sc1
    buffer_load_dwordx4 v[48:51], v15, s[24:27], s59 offen offset:3072 sc1
    buffer_load_dwordx4 v[52:55], v15, s[24:27], s10 offen offset:0 sc1
    s_add_u32 s59, s59, 81920
    s_add_u32 s10, s59, 4096
    buffer_load_dwordx4 v[56:59], v15, s[24:27], s59 offen offset:0 sc1
    buffer_load_dwordx4 v[60:63], v15, s[24:27], s59 offen offset:1024 sc1
    buffer_load_dwordx4 v[64:67], v15, s[24:27], s59 offen offset:2048 sc1
    buffer_load_dwordx4 v[68:71], v15, s[24:27], s59 offen offset:3072 sc1
    buffer_load_dwordx4 v[72:75], v15, s[24:27], s10 offen offset:0 sc1
    s_add_u32 s59, s59, 81920
    s_barrier
    s_add_u32 s10, s59, 4096
    buffer_load_dwordx4 v[76:79], v15, s[24:27], s59 offen offset:0 sc1
    buffer_load_dwordx4 v[80:83], v15, s[24:27], s59 offen offset:1024 sc1
    buffer_load_dwordx4 v[84:87], v15, s[24:27], s59 offen offset:2048 sc1
    buffer_load_dwordx4 v[88:91], v15, s[24:27], s59 offen offset:3072 sc1
    buffer_load_dwordx4 v[92:95], v15, s[24:27], s10 offen offset:0 sc1
    s_add_u32 s59, s59, 81920
    s_add_u32 s10, s59, 4096
    buffer_load_dwordx4 v[96:99], v15, s[24:27], s59 offen offset:0 sc1
    buffer_load_dwordx4 v[100:103], v15, s[24:27], s59 offen offset:1024 sc1
    buffer_load_dwordx4 v[104:107], v15, s[24:27], s59 offen offset:2048 sc1
    buffer_load_dwordx4 v[108:111], v15, s[24:27], s59 offen offset:3072 sc1
    buffer_load_dwordx4 v[112:115], v15, s[24:27], s10 offen offset:0 sc1
    s_add_u32 s59, s59, 81920
    s_add_u32 s10, s59, 4096
    buffer_load_dwordx4 v[116:119], v15, s[24:27], s59 offen offset:0 sc1
    buffer_load_dwordx4 v[120:123], v15, s[24:27], s59 offen offset:1024 sc1
    buffer_load_dwordx4 v[124:127], v15, s[24:27], s59 offen offset:2048 sc1
    buffer_load_dwordx4 v[128:131], v15, s[24:27], s59 offen offset:3072 sc1
    buffer_load_dwordx4 v[132:135], v15, s[24:27], s10 offen offset:0 sc1
    s_add_u32 s59, s59, 81920
    s_mul_i32 s10, s55, 384
    s_add_u32 s10, s10, 27262976
    buffer_load_dwordx4 v[140:143], v180, s[24:27], s10 offen sc1
    s_add_u32 s10, s10, 12288
    buffer_load_dwordx4 v[144:147], v180, s[24:27], s10 offen sc1
    s_add_u32 s10, s10, 12288
    buffer_load_dwordx4 v[148:151], v180, s[24:27], s10 offen sc1
    s_add_u32 s10, s10, 12288
    buffer_load_dwordx4 v[152:155], v180, s[24:27], s10 offen sc1
    s_add_u32 s10, s10, 12288
    buffer_load_dwordx4 v[156:159], v180, s[24:27], s10 offen sc1
    s_add_u32 s10, s10, 12288
    buffer_load_dwordx4 v[160:163], v180, s[24:27], s10 offen sc1
    s_add_u32 s10, s10, 12288
    buffer_load_dwordx4 v[164:167], v180, s[24:27], s10 offen sc1
    s_add_u32 s10, s10, 12288
    buffer_load_dwordx4 v[168:171], v180, s[24:27], s10 offen sc1
    s_add_u32 s10, s10, 12288
    buffer_load_dwordx4 v[172:175], v180, s[24:27], s10 offen sc1
    s_add_u32 s10, s10, 12288
    buffer_load_dwordx4 v[176:179], v180, s[24:27], s10 offen sc1
    s_add_u32 s10, s10, 12288
    s_barrier
    s_branch SV_att_done
K2_helper:
    s_mov_b32 s16, s12
    s_and_b32 s17, s13, 0xffff
    s_mov_b32 s18, 1966080
    s_mov_b32 s19, 0x00020000
    s_mov_b32 s20, s14
    s_and_b32 s21, s15, 0xffff
    s_mov_b32 s22, 1966080
    s_mov_b32 s23, 0x00020000
    s_mov_b32 s44, s4
    s_and_b32 s45, s5, 0xffff
    s_mov_b32 s46, 819200
    s_mov_b32 s47, 0x00020000
    s_mov_b32 s60, s6
    s_and_b32 s61, s7, 0xffff
    s_mov_b32 s62, 1966080
    s_mov_b32 s63, 0x00020000
    s_sub_u32 s11, s28, 5
    v_lshlrev_b32 v15, 4, v0
    v_lshrrev_b32 v1, 3, v0
    v_and_b32 v2, 7, v0
    v_mul_u32_u24 v3, 3072, v1
    v_lshl_add_u32 v3, v2, 4, v3
    v_add_u32 v4, 24576, v3
    v_add_u32 v9, 49152, v3
    v_add_u32 v10, 73728, v3
    v_mul_u32_u24 v5, 1280, v1
    v_lshl_add_u32 v5, v2, 4, v5
    v_add_u32 v6, 10240, v5
    v_add_u32 v7, 20480, v5
    v_add_u32 v8, 30720, v5
    s_mul_i32 s31, s2, 3
    s_add_u32 s31, s31, s11
    s_lshl_b32 s32, s11, 12
    s_add_u32 s32, s32, 139264
    v_and_b32 v1, 15, v0
    v_lshrrev_b32 v2, 4, v0
    v_lshrrev_b32 v11, 2, v1
    v_and_b32 v12, 3, v1
    v_lshl_add_u32 v13, v2, 3, v11
    v_lshlrev_b32 v13, 7, v13
    v_lshl_add_u32 v13, v12, 3, v13
    v_add_u32 v13, s32, v13
    v_lshrrev_b32 v14, 5, v0
    v_mul_u32_u24 v14, 20480, v14
    v_add_u32 v14, v14, v5
    v_add_u32 v40, 0, v0
    v_mul_u32_u24 v41, 6554, v40
    v_lshrrev_b32 v41, 16, v41
    v_mul_u32_u24 v41, 1120, v41
    v_lshl_add_u32 v42, v40, 4, v41
    v_add_u32 v40, 64, v0
    v_mul_u32_u24 v41, 6554, v40
    v_lshrrev_b32 v41, 16, v41
    v_mul_u32_u24 v41, 1120, v41
    v_lshl_add_u32 v43, v40, 4, v41
    v_add_u32 v40, 128, v0
    v_mul_u32_u24 v41, 6554, v40
    v_lshrrev_b32 v41, 16, v41
    v_mul_u32_u24 v41, 1120, v41
    v_lshl_add_u32 v44, v40, 4, v41
    v_add_u32 v40, 192, v0
    v_mul_u32_u24 v41, 6554, v40
    v_lshrrev_b32 v41, 16, v41
    v_mul_u32_u24 v41, 1120, v41
    v_lshl_add_u32 v45, v40, 4, v41
    v_add_u32 v40, 256, v0
    v_mul_u32_u24 v41, 6554, v40
    v_lshrrev_b32 v41, 16, v41
    v_mul_u32_u24 v41, 1120, v41
    v_lshl_add_u32 v46, v40, 4, v41
    v_add_u32 v40, 320, v0
    v_mul_u32_u24 v41, 6554, v40
    v_lshrrev_b32 v41, 16, v41
    v_mul_u32_u24 v41, 1120, v41
    v_lshl_add_u32 v47, v40, 4, v41
    v_add_u32 v40, 384, v0
    v_mul_u32_u24 v41, 6554, v40
    v_lshrrev_b32 v41, 16, v41
    v_mul_u32_u24 v41, 1120, v41
    v_lshl_add_u32 v48, v40, 4, v41
    v_add_u32 v40, 448, v0
    v_mul_u32_u24 v41, 6554, v40
    v_lshrrev_b32 v41, 16, v41
    v_mul_u32_u24 v41, 1120, v41
    v_lshl_add_u32 v49, v40, 4, v41
    v_add_u32 v40, 512, v0
    v_mul_u32_u24 v41, 6554, v40
    v_lshrrev_b32 v41, 16, v41
    v_mul_u32_u24 v41, 1120, v41
    v_lshl_add_u32 v50, v40, 4, v41
    v_add_u32 v40, 576, v0
    v_mul_u32_u24 v41, 6554, v40
    v_lshrrev_b32 v41, 16, v41
    v_mul_u32_u24 v41, 1120, v41
    v_lshl_add_u32 v51, v40, 4, v41
    v_mov_b32 v60, 0
    v_mov_b32 v61, 1
    v_lshlrev_b32 v36, 2, v0
    v_add_u32 v180, 5760, v15
    v_cmp_gt_u32 vcc, 24, v0
    s_nop 1
    v_cndmask_b32 v180, v180, v15, vcc
    s_waitcnt vmcnt(0)
    s_barrier
H_round:
    s_sleep 0
    s_lshl_b32 s33, s31, 12
    s_add_u32 s33, s33, 20316160
    s_cmp_ge_u32 s31, 1640
    s_cbranch_scc1 H_n
    s_cmp_ge_u32 s31, 960
    s_cbranch_scc1 H_d
    s_mul_i32 s10, s31, 2731
    s_lshr_b32 s10, s10, 16
    s_mul_i32 s11, s10, 24
    s_sub_u32 s11, s31, s11
    s_and_b32 s34, s10, 1
    s_lshr_b32 s10, s10, 1
    s_mul_i32 s10, s10, 98304
    s_lshl_b32 s11, s11, 7
    s_add_u32 s10, s10, s11
    s_cmp_eq_u32 s34, 1
    s_cbranch_scc1 H_u
    s_add_u32 m0, s32, 0
    s_nop 0
    buffer_load_dwordx4 v3, s[16:19], s10 offen lds
    s_add_u32 m0, s32, 1024
    s_nop 0
    buffer_load_dwordx4 v4, s[16:19], s10 offen lds
    s_add_u32 m0, s32, 2048
    s_nop 0
    buffer_load_dwordx4 v9, s[16:19], s10 offen lds
    s_add_u32 m0, s32, 3072
    s_nop 0
    buffer_load_dwordx4 v10, s[16:19], s10 offen lds
    s_branch H_n
H_u:
    s_add_u32 m0, s32, 0
    s_nop 0
    buffer_load_dwordx4 v3, s[20:23], s10 offen lds
    s_add_u32 m0, s32, 1024
    s_nop 0
    buffer_load_dwordx4 v4, s[20:23], s10 offen lds
    s_add_u32 m0, s32, 2048
    s_nop 0
    buffer_load_dwordx4 v9, s[20:23], s10 offen lds
    s_add_u32 m0, s32, 3072
    s_nop 0
    buffer_load_dwordx4 v10, s[20:23], s10 offen lds
    s_branch H_n
H_d:
    s_cmp_ge_u32 s31, 1440
    s_cselect_b32 s34, 480, 0
    s_sub_u32 s34, s31, s34
    s_sub_u32 s34, s34, 960
    s_mul_i32 s10, s34, 6554
    s_lshr_b32 s10, s10, 16
    s_mul_i32 s11, s10, 10
    s_sub_u32 s11, s34, s11
    s_mul_i32 s10, s10, 40960
    s_lshl_b32 s11, s11, 7
    s_add_u32 s10, s10, s11
    s_cmp_ge_u32 s31, 1440
    s_cbranch_scc1 H_o
    s_add_u32 m0, s32, 0
    s_nop 0
    buffer_load_dwordx4 v5, s[60:63], s10 offen lds
    s_add_u32 m0, s32, 1024
    s_nop 0
    buffer_load_dwordx4 v6, s[60:63], s10 offen lds
    s_add_u32 m0, s32, 2048
    s_nop 0
    buffer_load_dwordx4 v7, s[60:63], s10 offen lds
    s_add_u32 m0, s32, 3072
    s_nop 0
    buffer_load_dwordx4 v8, s[60:63], s10 offen lds
    s_branch H_n
H_o:
    s_mul_i32 s10, s34, 6554
    s_lshr_b32 s10, s10, 16
    s_cmp_lt_u32 s10, 4
    s_cbranch_scc1 H_ol
    s_sub_u32 s10, s10, 4
    s_mul_i32 s10, s10, 51200
    s_add_u32 s10, s10, s11
    s_add_u32 m0, s32, 0
    s_nop 0
    buffer_load_dwordx4 v5, s[44:47], s10 offen lds
    s_add_u32 m0, s32, 1024
    s_nop 0
    buffer_load_dwordx4 v6, s[44:47], s10 offen lds
    s_add_u32 s10, s10, 25600
    s_add_u32 m0, s32, 2048
    s_nop 0
    buffer_load_dwordx4 v5, s[44:47], s10 offen lds
    s_add_u32 m0, s32, 3072
    s_nop 0
    buffer_load_dwordx4 v6, s[44:47], s10 offen lds
    s_branch H_n
H_ol:
    s_mul_i32 s10, s10, 204800
    s_add_u32 s10, s10, s11
    s_add_u32 s10, s10, 20480
    s_add_u32 m0, s32, 0
    s_nop 0
    buffer_load_dwordx4 v14, s[44:47], s10 offen lds
    s_add_u32 s10, s10, 51200
    s_add_u32 m0, s32, 1024
    s_nop 0
    buffer_load_dwordx4 v14, s[44:47], s10 offen lds
    s_add_u32 s10, s10, 51200
    s_add_u32 m0, s32, 2048
    s_nop 0
    buffer_load_dwordx4 v14, s[44:47], s10 offen lds
    s_add_u32 s10, s10, 51200
    s_add_u32 m0, s32, 3072
    s_nop 0
    buffer_load_dwordx4 v14, s[44:47], s10 offen lds
    s_add_u32 s10, s10, 51200
H_n:
    s_barrier
    s_cmp_ge_u32 s31, 1640
    s_cbranch_scc1 H_e
    s_waitcnt vmcnt(0)
    ds_read_b64_tr_b16 v[16:17], v13 offset:0
    ds_read_b64_tr_b16 v[18:19], v13 offset:512
    ds_read_b64_tr_b16 v[20:21], v13 offset:32
    ds_read_b64_tr_b16 v[22:23], v13 offset:544
    ds_read_b64_tr_b16 v[24:25], v13 offset:64
    ds_read_b64_tr_b16 v[26:27], v13 offset:576
    ds_read_b64_tr_b16 v[28:29], v13 offset:96
    ds_read_b64_tr_b16 v[30:31], v13 offset:608
    s_waitcnt lgkmcnt(0)
    buffer_store_dwordx4 v[16:19], v15, s[24:27], s33 offen offset:0 sc1
    buffer_store_dwordx4 v[20:23], v15, s[24:27], s33 offen offset:1024 sc1
    buffer_store_dwordx4 v[24:27], v15, s[24:27], s33 offen offset:2048 sc1
    buffer_store_dwordx4 v[28:31], v15, s[24:27], s33 offen offset:3072 sc1
    s_cmp_ge_u32 s31, 960
    s_cbranch_scc1 H_e
    s_mov_b32 s10, 0x3f803f80
    s_setprio 3
    v_dot2_f32_bf16 v32, v16, s10, 0
    v_dot2_f32_bf16 v33, v20, s10, 0
    v_dot2_f32_bf16 v34, v24, s10, 0
    v_dot2_f32_bf16 v35, v28, s10, 0
    v_dot2_f32_bf16 v32, v17, s10, v32
    v_dot2_f32_bf16 v33, v21, s10, v33
    v_dot2_f32_bf16 v34, v25, s10, v34
    v_dot2_f32_bf16 v35, v29, s10, v35
    v_dot2_f32_bf16 v32, v18, s10, v32
    v_dot2_f32_bf16 v33, v22, s10, v33
    v_dot2_f32_bf16 v34, v26, s10, v34
    v_dot2_f32_bf16 v35, v30, s10, v35
    v_dot2_f32_bf16 v32, v19, s10, v32
    v_dot2_f32_bf16 v33, v23, s10, v33
    v_dot2_f32_bf16 v34, v27, s10, v34
    v_dot2_f32_bf16 v35, v31, s10, v35
    s_lshl_b32 s10, s31, 8
    s_add_u32 s10, s10, 27262976
    s_nop 1
    v_permlane32_swap_b32 v32, v34
    v_permlane32_swap_b32 v33, v35
    v_add_f32 v32, v32, v34
    v_add_f32 v33, v33, v35
    s_nop 1
    v_permlane16_swap_b32 v32, v33
    v_add_f32 v32, v32, v33
    s_setprio 0
    buffer_store_dword v32, v36, s[24:27], s10 offen sc1
H_e:
    s_add_u32 s31, s31, 768
    s_cmp_lt_u32 s31, 2304
    s_cbranch_scc1 H_round
    s_waitcnt vmcnt(0)
    s_barrier
    s_cmp_lg_u32 s28, 5
    s_cbranch_scc1 H_w
    s_lshl_b32 s10, s3, 8
    s_add_u32 s10, s10, 27090944
    s_mov_b64 exec, 1
    buffer_atomic_add v61, v60, s[24:27], s10 offen sc1
    s_mov_b64 exec, -1
    s_mov_b32 s16, s50
    s_and_b32 s17, s51, 0xffff
    s_mov_b32 s18, 2621440
    s_mov_b32 s19, 0x00020000
    s_mul_i32 s38, s56, 81920
    s_mul_i32 s10, s57, 160
    s_add_u32 s38, s38, s10
    s_mov_b32 m0, 151552
    s_nop 0
    buffer_load_dwordx4 v42, s[16:19], s38 offen lds
    s_mov_b32 m0, 152576
    s_nop 0
    buffer_load_dwordx4 v43, s[16:19], s38 offen lds
    s_mov_b32 m0, 153600
    s_nop 0
    buffer_load_dwordx4 v44, s[16:19], s38 offen lds
    s_mov_b32 m0, 154624
    s_nop 0
    buffer_load_dwordx4 v45, s[16:19], s38 offen lds
    s_mov_b32 m0, 155648
    s_nop 0
    buffer_load_dwordx4 v46, s[16:19], s38 offen lds
    s_mov_b32 m0, 156672
    s_nop 0
    buffer_load_dwordx4 v47, s[16:19], s38 offen lds
    s_mov_b32 m0, 157696
    s_nop 0
    buffer_load_dwordx4 v48, s[16:19], s38 offen lds
    s_mov_b32 m0, 158720
    s_nop 0
    buffer_load_dwordx4 v49, s[16:19], s38 offen lds
    s_mov_b32 m0, 159744
    s_nop 0
    buffer_load_dwordx4 v50, s[16:19], s38 offen lds
    s_mov_b32 m0, 160768
    s_nop 0
    buffer_load_dwordx4 v51, s[16:19], s38 offen lds
    s_barrier
    s_setprio 3
    v_lshlrev_b32 v1, 8, v0
    s_mov_b32 s10, 27090944
    s_mov_b32 s11, 0
    s_mov_b64 exec, 0xff
PW5_poll:
    buffer_load_dword v2, v1, s[24:27], s10 offen sc1
    s_add_u32 s11, s11, 1
    s_waitcnt vmcnt(0)
    v_cmp_gt_u32 vcc, 32, v2
    s_nop 0
    s_cmp_eq_u64 vcc, 0
    s_cbranch_scc1 PW5_got
    s_sleep 8
    s_cmp_lt_u32 s11, 0x4000
    s_cbranch_scc1 PW5_poll
PW5_got:
    s_mov_b64 exec, -1
    s_setprio 0
    s_and_b32 s11, s28, 1
    s_and_b32 s48, s28, 3
    s_mul_i32 s58, s55, 6144
    s_mul_i32 s10, s48, 98304
    s_add_u32 s58, s58, s10
    s_add_u32 s58, s58, 20316160
    s_mul_i32 s59, s57, 5120
    s_mul_i32 s10, s11, 40960
    s_add_u32 s59, s59, s10
    s_lshr_b32 s10, s48, 1
    s_mul_i32 s10, s10, 491520
    s_add_u32 s59, s59, s10
    s_add_u32 s59, s59, 24739840
    s_add_u32 s10, s58, 4096
    buffer_load_dwordx4 v[184:187], v15, s[24:27], s58 offen offset:0 sc1
    buffer_load_dwordx4 v[188:191], v15, s[24:27], s58 offen offset:1024 sc1
    buffer_load_dwordx4 v[192:195], v15, s[24:27], s58 offen offset:2048 sc1
    buffer_load_dwordx4 v[196:199], v15, s[24:27], s58 offen offset:3072 sc1
    buffer_load_dwordx4 v[200:203], v15, s[24:27], s10 offen offset:0 sc1
    buffer_load_dwordx4 v[204:207], v15, s[24:27], s10 offen offset:1024 sc1
    s_add_u32 s58, s58, 393216
    s_add_u32 s10, s58, 4096
    buffer_load_dwordx4 v[208:211], v15, s[24:27], s58 offen offset:0 sc1
    buffer_load_dwordx4 v[212:215], v15, s[24:27], s58 offen offset:1024 sc1
    buffer_load_dwordx4 v[216:219], v15, s[24:27], s58 offen offset:2048 sc1
    buffer_load_dwordx4 v[220:223], v15, s[24:27], s58 offen offset:3072 sc1
    buffer_load_dwordx4 v[224:227], v15, s[24:27], s10 offen offset:0 sc1
    buffer_load_dwordx4 v[228:231], v15, s[24:27], s10 offen offset:1024 sc1
    s_add_u32 s58, s58, 393216
    s_add_u32 s10, s58, 4096
    buffer_load_dwordx4 v[232:235], v15, s[24:27], s58 offen offset:0 sc1
    buffer_load_dwordx4 v[236:239], v15, s[24:27], s58 offen offset:1024 sc1
    buffer_load_dwordx4 v[240:243], v15, s[24:27], s58 offen offset:2048 sc1
    buffer_load_dwordx4 v[244:247], v15, s[24:27], s58 offen offset:3072 sc1
    buffer_load_dwordx4 v[248:251], v15, s[24:27], s10 offen offset:0 sc1
    buffer_load_dwordx4 v[252:255], v15, s[24:27], s10 offen offset:1024 sc1
    s_add_u32 s58, s58, 393216
    s_add_u32 s10, s59, 4096
    buffer_load_dwordx4 v[16:19], v15, s[24:27], s59 offen offset:0 sc1
    buffer_load_dwordx4 v[20:23], v15, s[24:27], s59 offen offset:1024 sc1
    buffer_load_dwordx4 v[24:27], v15, s[24:27], s59 offen offset:2048 sc1
    buffer_load_dwordx4 v[28:31], v15, s[24:27], s59 offen offset:3072 sc1
    buffer_load_dwordx4 v[32:35], v15, s[24:27], s10 offen offset:0 sc1
    s_add_u32 s59, s59, 81920
    s_add_u32 s10, s59, 4096
    buffer_load_dwordx4 v[36:39], v15, s[24:27], s59 offen offset:0 sc1
    buffer_load_dwordx4 v[40:43], v15, s[24:27], s59 offen offset:1024 sc1
    buffer_load_dwordx4 v[44:47], v15, s[24:27], s59 offen offset:2048 sc1
    buffer_load_dwordx4 v[48:51], v15, s[24:27], s59 offen offset:3072 sc1
    buffer_load_dwordx4 v[52:55], v15, s[24:27], s10 offen offset:0 sc1
    s_add_u32 s59, s59, 81920
    s_barrier
    s_add_u32 s10, s59, 4096
    buffer_load_dwordx4 v[56:59], v15, s[24:27], s59 offen offset:0 sc1
    buffer_load_dwordx4 v[60:63], v15, s[24:27], s59 offen offset:1024 sc1
    buffer_load_dwordx4 v[64:67], v15, s[24:27], s59 offen offset:2048 sc1
    buffer_load_dwordx4 v[68:71], v15, s[24:27], s59 offen offset:3072 sc1
    buffer_load_dwordx4 v[72:75], v15, s[24:27], s10 offen offset:0 sc1
    s_add_u32 s59, s59, 81920
    s_add_u32 s10, s59, 4096
    buffer_load_dwordx4 v[76:79], v15, s[24:27], s59 offen offset:0 sc1
    buffer_load_dwordx4 v[80:83], v15, s[24:27], s59 offen offset:1024 sc1
    buffer_load_dwordx4 v[84:87], v15, s[24:27], s59 offen offset:2048 sc1
    buffer_load_dwordx4 v[88:91], v15, s[24:27], s59 offen offset:3072 sc1
    buffer_load_dwordx4 v[92:95], v15, s[24:27], s10 offen offset:0 sc1
    s_add_u32 s59, s59, 81920
    s_barrier
    s_add_u32 s10, s59, 4096
    buffer_load_dwordx4 v[96:99], v15, s[24:27], s59 offen offset:0 sc1
    buffer_load_dwordx4 v[100:103], v15, s[24:27], s59 offen offset:1024 sc1
    buffer_load_dwordx4 v[104:107], v15, s[24:27], s59 offen offset:2048 sc1
    buffer_load_dwordx4 v[108:111], v15, s[24:27], s59 offen offset:3072 sc1
    buffer_load_dwordx4 v[112:115], v15, s[24:27], s10 offen offset:0 sc1
    s_add_u32 s59, s59, 81920
    s_add_u32 s10, s59, 4096
    buffer_load_dwordx4 v[116:119], v15, s[24:27], s59 offen offset:0 sc1
    buffer_load_dwordx4 v[120:123], v15, s[24:27], s59 offen offset:1024 sc1
    buffer_load_dwordx4 v[124:127], v15, s[24:27], s59 offen offset:2048 sc1
    buffer_load_dwordx4 v[128:131], v15, s[24:27], s59 offen offset:3072 sc1
    buffer_load_dwordx4 v[132:135], v15, s[24:27], s10 offen offset:0 sc1
    s_add_u32 s59, s59, 81920
    s_mul_i32 s10, s55, 384
    s_add_u32 s10, s10, 27385856
    buffer_load_dwordx4 v[140:143], v180, s[24:27], s10 offen sc1
    s_add_u32 s10, s10, 12288
    buffer_load_dwordx4 v[144:147], v180, s[24:27], s10 offen sc1
    s_add_u32 s10, s10, 12288
    buffer_load_dwordx4 v[148:151], v180, s[24:27], s10 offen sc1
    s_add_u32 s10, s10, 12288
    buffer_load_dwordx4 v[152:155], v180, s[24:27], s10 offen sc1
    s_add_u32 s10, s10, 12288
    buffer_load_dwordx4 v[156:159], v180, s[24:27], s10 offen sc1
    s_add_u32 s10, s10, 12288
    buffer_load_dwordx4 v[160:163], v180, s[24:27], s10 offen sc1
    s_add_u32 s10, s10, 12288
    buffer_load_dwordx4 v[164:167], v180, s[24:27], s10 offen sc1
    s_add_u32 s10, s10, 12288
    buffer_load_dwordx4 v[168:171], v180, s[24:27], s10 offen sc1
    s_add_u32 s10, s10, 12288
    buffer_load_dwordx4 v[172:175], v180, s[24:27], s10 offen sc1
    s_add_u32 s10, s10, 12288
    buffer_load_dwordx4 v[176:179], v180, s[24:27], s10 offen sc1
    s_add_u32 s10, s10, 12288
    s_lshr_b32 s10, s2, 3
    s_cmp_ge_u32 s10, 5
    s_cbranch_scc1 H_noct
    s_getpc_b64 s[44:45]
CT_2:
    s_sub_u32 s44, s44, CT_2-qkv_kernel
    s_subb_u32 s45, s45, 0
    s_and_b32 s45, s45, 0xffff
    s_mov_b32 s46, CODE_END-qkv_kernel
    s_mov_b32 s47, 0x00020000
    s_lshl_b32 s10, s10, 13
    v_lshlrev_b32 v1, 7, v0
    v_add_u32 v1, s10, v1
    buffer_load_dword v2, v1, s[44:47], 0 offen
H_noct:
    s_barrier
    s_branch SV_att_done
H_w:
    s_barrier
    s_setprio 3
    v_lshlrev_b32 v1, 8, v0
    s_mov_b32 s10, 27090944
    s_mov_b32 s11, 0
    s_mov_b64 exec, 0xff
PW6_poll:
    buffer_load_dword v2, v1, s[24:27], s10 offen sc1
    s_add_u32 s11, s11, 1
    s_waitcnt vmcnt(0)
    v_cmp_gt_u32 vcc, 32, v2
    s_nop 0
    s_cmp_eq_u64 vcc, 0
    s_cbranch_scc1 PW6_got
    s_sleep 8
    s_cmp_lt_u32 s11, 0x4000
    s_cbranch_scc1 PW6_poll
PW6_got:
    s_mov_b64 exec, -1
    s_setprio 0
    s_and_b32 s11, s28, 1
    s_and_b32 s48, s28, 3
    s_mul_i32 s58, s55, 6144
    s_mul_i32 s10, s48, 98304
    s_add_u32 s58, s58, s10
    s_add_u32 s58, s58, 20316160
    s_mul_i32 s59, s57, 5120
    s_mul_i32 s10, s11, 40960
    s_add_u32 s59, s59, s10
    s_lshr_b32 s10, s48, 1
    s_mul_i32 s10, s10, 491520
    s_add_u32 s59, s59, s10
    s_add_u32 s59, s59, 24739840
    s_mul_i32 s42, s57, 5120
    s_mul_i32 s10, s11, 40960
    s_add_u32 s42, s42, s10
    s_add_u32 s42, s42, 26542080
    s_mul_i32 s33, s11, 5120
    s_add_u32 s34, s33, 90112
    s_mov_b32 s35, 0
H_pw:
    s_mov_b32 m0, s34
    s_add_u32 s37, s42, 4096
    buffer_load_dwordx4 v15, s[24:27], s42 offen sc1 lds
    buffer_load_dwordx4 v15, s[24:27], s42 offen offset:1024 sc1 lds
    buffer_load_dwordx4 v15, s[24:27], s42 offen offset:2048 sc1 lds
    buffer_load_dwordx4 v15, s[24:27], s42 offen offset:3072 sc1 lds
    s_add_u32 m0, s34, 4096
    s_add_u32 s42, s42, 81920
    buffer_load_dwordx4 v15, s[24:27], s37 offen sc1 lds
    s_add_u32 s34, s34, 10240
    s_add_u32 s35, s35, 1
    s_cmp_lg_u32 s35, 6
    s_cbranch_scc1 H_pw2
    s_sub_u32 s42, s42, 819200
    s_sub_u32 s34, s34, 102400
    s_barrier
H_pw2:
    s_cmp_lt_u32 s35, 10
    s_cbranch_scc1 H_pw
    s_add_u32 s10, s58, 4096
    buffer_load_dwordx4 v[184:187], v15, s[24:27], s58 offen offset:0 sc1
    buffer_load_dwordx4 v[188:191], v15, s[24:27], s58 offen offset:1024 sc1
    buffer_load_dwordx4 v[192:195], v15, s[24:27], s58 offen offset:2048 sc1
    buffer_load_dwordx4 v[196:199], v15, s[24:27], s58 offen offset:3072 sc1
    buffer_load_dwordx4 v[200:203], v15, s[24:27], s10 offen offset:0 sc1
    buffer_load_dwordx4 v[204:207], v15, s[24:27], s10 offen offset:1024 sc1
    s_add_u32 s58, s58, 393216
    s_add_u32 s10, s58, 4096
    buffer_load_dwordx4 v[208:211], v15, s[24:27], s58 offen offset:0 sc1
    buffer_load_dwordx4 v[212:215], v15, s[24:27], s58 offen offset:1024 sc1
    buffer_load_dwordx4 v[216:219], v15, s[24:27], s58 offen offset:2048 sc1
    buffer_load_dwordx4 v[220:223], v15, s[24:27], s58 offen offset:3072 sc1
    buffer_load_dwordx4 v[224:227], v15, s[24:27], s10 offen offset:0 sc1
    buffer_load_dwordx4 v[228:231], v15, s[24:27], s10 offen offset:1024 sc1
    s_add_u32 s58, s58, 393216
    s_add_u32 s10, s58, 4096
    buffer_load_dwordx4 v[232:235], v15, s[24:27], s58 offen offset:0 sc1
    buffer_load_dwordx4 v[236:239], v15, s[24:27], s58 offen offset:1024 sc1
    buffer_load_dwordx4 v[240:243], v15, s[24:27], s58 offen offset:2048 sc1
    buffer_load_dwordx4 v[244:247], v15, s[24:27], s58 offen offset:3072 sc1
    buffer_load_dwordx4 v[248:251], v15, s[24:27], s10 offen offset:0 sc1
    buffer_load_dwordx4 v[252:255], v15, s[24:27], s10 offen offset:1024 sc1
    s_add_u32 s58, s58, 393216
    s_barrier
    s_add_u32 s10, s59, 4096
    buffer_load_dwordx4 v[16:19], v15, s[24:27], s59 offen offset:0 sc1
    buffer_load_dwordx4 v[20:23], v15, s[24:27], s59 offen offset:1024 sc1
    buffer_load_dwordx4 v[24:27], v15, s[24:27], s59 offen offset:2048 sc1
    buffer_load_dwordx4 v[28:31], v15, s[24:27], s59 offen offset:3072 sc1
    buffer_load_dwordx4 v[32:35], v15, s[24:27], s10 offen offset:0 sc1
    s_add_u32 s59, s59, 81920
    s_add_u32 s10, s59, 4096
    buffer_load_dwordx4 v[36:39], v15, s[24:27], s59 offen offset:0 sc1
    buffer_load_dwordx4 v[40:43], v15, s[24:27], s59 offen offset:1024 sc1
    buffer_load_dwordx4 v[44:47], v15, s[24:27], s59 offen offset:2048 sc1
    buffer_load_dwordx4 v[48:51], v15, s[24:27], s59 offen offset:3072 sc1
    buffer_load_dwordx4 v[52:55], v15, s[24:27], s10 offen offset:0 sc1
    s_add_u32 s59, s59, 81920
    s_add_u32 s10, s59, 4096
    buffer_load_dwordx4 v[56:59], v15, s[24:27], s59 offen offset:0 sc1
    buffer_load_dwordx4 v[60:63], v15, s[24:27], s59 offen offset:1024 sc1
    buffer_load_dwordx4 v[64:67], v15, s[24:27], s59 offen offset:2048 sc1
    buffer_load_dwordx4 v[68:71], v15, s[24:27], s59 offen offset:3072 sc1
    buffer_load_dwordx4 v[72:75], v15, s[24:27], s10 offen offset:0 sc1
    s_add_u32 s59, s59, 81920
    s_add_u32 s10, s59, 4096
    buffer_load_dwordx4 v[76:79], v15, s[24:27], s59 offen offset:0 sc1
    buffer_load_dwordx4 v[80:83], v15, s[24:27], s59 offen offset:1024 sc1
    buffer_load_dwordx4 v[84:87], v15, s[24:27], s59 offen offset:2048 sc1
    buffer_load_dwordx4 v[88:91], v15, s[24:27], s59 offen offset:3072 sc1
    buffer_load_dwordx4 v[92:95], v15, s[24:27], s10 offen offset:0 sc1
    s_add_u32 s59, s59, 81920
    s_add_u32 s10, s59, 4096
    buffer_load_dwordx4 v[96:99], v15, s[24:27], s59 offen offset:0 sc1
    buffer_load_dwordx4 v[100:103], v15, s[24:27], s59 offen offset:1024 sc1
    buffer_load_dwordx4 v[104:107], v15, s[24:27], s59 offen offset:2048 sc1
    buffer_load_dwordx4 v[108:111], v15, s[24:27], s59 offen offset:3072 sc1
    buffer_load_dwordx4 v[112:115], v15, s[24:27], s10 offen offset:0 sc1
    s_add_u32 s59, s59, 81920
    s_add_u32 s10, s59, 4096
    buffer_load_dwordx4 v[116:119], v15, s[24:27], s59 offen offset:0 sc1
    buffer_load_dwordx4 v[120:123], v15, s[24:27], s59 offen offset:1024 sc1
    buffer_load_dwordx4 v[124:127], v15, s[24:27], s59 offen offset:2048 sc1
    buffer_load_dwordx4 v[128:131], v15, s[24:27], s59 offen offset:3072 sc1
    buffer_load_dwordx4 v[132:135], v15, s[24:27], s10 offen offset:0 sc1
    s_add_u32 s59, s59, 81920
    s_add_u32 s10, s59, 4096
    buffer_load_dwordx4 v[136:139], v15, s[24:27], s59 offen offset:0 sc1
    buffer_load_dwordx4 v[140:143], v15, s[24:27], s59 offen offset:1024 sc1
    buffer_load_dwordx4 v[144:147], v15, s[24:27], s59 offen offset:2048 sc1
    buffer_load_dwordx4 v[148:151], v15, s[24:27], s59 offen offset:3072 sc1
    buffer_load_dwordx4 v[152:155], v15, s[24:27], s10 offen offset:0 sc1
    s_add_u32 s59, s59, 81920
    s_add_u32 s10, s59, 4096
    buffer_load_dwordx4 v[156:159], v15, s[24:27], s59 offen offset:0 sc1
    buffer_load_dwordx4 v[160:163], v15, s[24:27], s59 offen offset:1024 sc1
    buffer_load_dwordx4 v[164:167], v15, s[24:27], s59 offen offset:2048 sc1
    buffer_load_dwordx4 v[168:171], v15, s[24:27], s59 offen offset:3072 sc1
    buffer_load_dwordx4 v[172:175], v15, s[24:27], s10 offen offset:0 sc1
    s_add_u32 s59, s59, 81920
    s_barrier
SV_att_done:
    s_and_b32 s11, s28, 1
    s_mul_i32 s43, s56, 81920
    s_lshl_b32 s33, s11, 12
    s_add_u32 s43, s43, s33
    s_add_u32 s43, s43, 8388608
    s_mov_b32 s34, 0
    s_waitcnt vmcnt(0)
    s_mul_i32 s39, s30, 1024
    s_add_u32 s39, s39, 27066368
    s_lshl_b32 s38, s29, 2
    s_add_u32 s38, s38, s39
    v_lshlrev_b32 v9, 7, v0
    v_mov_b32 v8, 1
    s_lshl_b32 s10, s3, 7
    s_add_u32 s39, s39, s10
    v_lshlrev_b32 v1, 2, v0
    s_cmp_lg_u32 s28, 4
    s_barrier
    s_cbranch_scc1 SY1_e
    s_mov_b64 exec, 255
    buffer_store_dword v8, v9, s[24:27], s38 offen sc1
    s_mov_b32 exec_lo, 0xffffffff
    s_mov_b32 s11, 0
    buffer_load_dword v2, v1, s[24:27], s39 offen sc1
    s_sleep 3
    buffer_load_dword v6, v1, s[24:27], s39 offen sc1
    s_sleep 3
    buffer_load_dword v7, v1, s[24:27], s39 offen sc1
SY1_poll:
    s_waitcnt vmcnt(2)
    v_cmp_ne_u32 vcc, 1, v2
    s_nop 0
    s_cmp_eq_u64 vcc, 0
    s_cbranch_scc1 SY1_got
    buffer_load_dword v2, v1, s[24:27], s39 offen sc1
    s_waitcnt vmcnt(2)
    v_cmp_ne_u32 vcc, 1, v6
    s_nop 0
    s_cmp_eq_u64 vcc, 0
    s_cbranch_scc1 SY1_got
    buffer_load_dword v6, v1, s[24:27], s39 offen sc1
    s_waitcnt vmcnt(2)
    v_cmp_ne_u32 vcc, 1, v7
    s_nop 0
    s_cmp_eq_u64 vcc, 0
    s_cbranch_scc1 SY1_got
    buffer_load_dword v7, v1, s[24:27], s39 offen sc1
    s_add_u32 s11, s11, 1
    s_cmp_lt_u32 s11, 0x8000
    s_cbranch_scc1 SY1_poll
SY1_got:
    s_mov_b64 exec, -1
SY1_e:
    s_barrier
    s_cmp_ge_u32 s28, 6
    s_cbranch_scc1 SV_wo_w
    s_mov_b32 s35, 0
WO_a0:
    s_add_u32 m0, s33, s34
    s_add_u32 s34, s34, 8192
    buffer_load_dwordx4 v15, s[24:27], s43 offen sc1 lds
    buffer_load_dwordx4 v15, s[24:27], s43 offen offset:1024 sc1 lds
    buffer_load_dwordx4 v15, s[24:27], s43 offen offset:2048 sc1 lds
    buffer_load_dwordx4 v15, s[24:27], s43 offen offset:3072 sc1 lds
    s_add_u32 s43, s43, 8192
    s_cmp_eq_u32 s34, 49152
    s_cselect_b32 s34, 0, s34
    s_add_u32 s35, s35, 1
    s_cmp_lt_u32 s35, 5
    s_cbranch_scc1 WO_a0
WO_a1:
    s_waitcnt vmcnt(16)
    s_barrier
    s_add_u32 m0, s33, s34
    s_add_u32 s34, s34, 8192
    buffer_load_dwordx4 v15, s[24:27], s43 offen sc1 lds
    buffer_load_dwordx4 v15, s[24:27], s43 offen offset:1024 sc1 lds
    buffer_load_dwordx4 v15, s[24:27], s43 offen offset:2048 sc1 lds
    buffer_load_dwordx4 v15, s[24:27], s43 offen offset:3072 sc1 lds
    s_add_u32 s43, s43, 8192
    s_cmp_eq_u32 s34, 49152
    s_cselect_b32 s34, 0, s34
    s_add_u32 s35, s35, 1
    s_cmp_lt_u32 s35, 10
    s_cbranch_scc1 WO_a1
    s_waitcnt vmcnt(16)
    s_barrier
    s_waitcnt vmcnt(12)
    s_barrier
    s_waitcnt vmcnt(8)
    s_barrier
    s_waitcnt vmcnt(4)
    s_barrier
    s_waitcnt vmcnt(0)
    s_barrier
    s_branch SV_gu
SV_wo_w:
    s_barrier
    s_barrier
    s_barrier
    s_barrier
    s_barrier
    s_barrier
    s_barrier
    s_barrier
    s_barrier
    s_barrier
SV_gu:
    s_mov_b32 s42, s58
    s_mul_i32 s43, s54, 163840
    s_lshl_b32 s10, s48, 12
    s_add_u32 s43, s43, s10
    s_add_u32 s43, s43, 11010048
    s_mul_i32 s33, s48, 10240
    v_add_u32 v3, s33, v15
    v_add_u32 v5, 81920, v3
    s_and_b32 s10, s28, 1
    s_mul_i32 s10, s10, 3072
    s_add_u32 s10, s10, 122880
    v_add_u32 v4, s10, v15
    s_lshr_b32 s49, s55, 2
    s_barrier
    s_cmp_ge_u32 s28, 6
    s_cbranch_scc1 SV_ncs
    v_pk_add_f32 v[140:141], v[140:141], v[144:145]
    v_pk_add_f32 v[142:143], v[142:143], v[146:147]
    v_pk_add_f32 v[140:141], v[140:141], v[148:149]
    v_pk_add_f32 v[142:143], v[142:143], v[150:151]
    v_pk_add_f32 v[140:141], v[140:141], v[152:153]
    v_pk_add_f32 v[142:143], v[142:143], v[154:155]
    v_pk_add_f32 v[140:141], v[140:141], v[156:157]
    v_pk_add_f32 v[142:143], v[142:143], v[158:159]
    v_pk_add_f32 v[140:141], v[140:141], v[160:161]
    v_pk_add_f32 v[142:143], v[142:143], v[162:163]
    v_pk_add_f32 v[140:141], v[140:141], v[164:165]
    v_pk_add_f32 v[142:143], v[142:143], v[166:167]
    v_pk_add_f32 v[140:141], v[140:141], v[168:169]
    v_pk_add_f32 v[142:143], v[142:143], v[170:171]
    v_pk_add_f32 v[140:141], v[140:141], v[172:173]
    v_pk_add_f32 v[142:143], v[142:143], v[174:175]
    v_pk_add_f32 v[140:141], v[140:141], v[176:177]
    v_pk_add_f32 v[142:143], v[142:143], v[178:179]
    ds_write_b128 v4, v[140:143]
SV_ncs:
    ds_write_b128 v3, v[184:187] offset:4096
    ds_write_b128 v3, v[188:191] offset:5120
    ds_write_b128 v3, v[192:195] offset:6144
    ds_write_b128 v3, v[196:199] offset:7168
    ds_write_b128 v3, v[200:203] offset:8192
    ds_write_b128 v3, v[204:207] offset:9216
    ds_write_b128 v3, v[208:211] offset:45056
    ds_write_b128 v3, v[212:215] offset:46080
    ds_write_b128 v3, v[216:219] offset:47104
    ds_write_b128 v3, v[220:223] offset:48128
    ds_write_b128 v3, v[224:227] offset:49152
    ds_write_b128 v3, v[228:231] offset:50176
    ds_write_b128 v5, v[232:235] offset:4096
    ds_write_b128 v5, v[236:239] offset:5120
    ds_write_b128 v5, v[240:243] offset:6144
    ds_write_b128 v5, v[244:247] offset:7168
    ds_write_b128 v5, v[248:251] offset:8192
    ds_write_b128 v5, v[252:255] offset:9216
    s_mul_i32 s39, s54, 512
    s_add_u32 s39, s39, 27074560
    s_lshl_b32 s38, s55, 2
    s_add_u32 s38, s38, s39
    v_lshlrev_b32 v9, 7, v0
    v_mov_b32 v8, 1
    s_lshl_b32 s10, s49, 7
    s_add_u32 s39, s39, s10
    v_lshlrev_b32 v1, 2, v0
    s_cmp_lg_u32 s28, 4
    s_barrier
    s_cbranch_scc1 SY2_e
    s_mov_b64 exec, 15
    buffer_store_dword v8, v9, s[24:27], s38 offen sc1
    s_mov_b32 exec_lo, 0xffff
    s_mov_b32 s11, 0
    buffer_load_dword v2, v1, s[24:27], s39 offen sc1
    s_sleep 3
    buffer_load_dword v6, v1, s[24:27], s39 offen sc1
    s_sleep 3
    buffer_load_dword v7, v1, s[24:27], s39 offen sc1
SY2_poll:
    s_waitcnt vmcnt(2)
    v_cmp_ne_u32 vcc, 1, v2
    s_nop 0
    s_cmp_eq_u64 vcc, 0
    s_cbranch_scc1 SY2_got
    buffer_load_dword v2, v1, s[24:27], s39 offen sc1
    s_waitcnt vmcnt(2)
    v_cmp_ne_u32 vcc, 1, v6
    s_nop 0
    s_cmp_eq_u64 vcc, 0
    s_cbranch_scc1 SY2_got
    buffer_load_dword v6, v1, s[24:27], s39 offen sc1
    s_waitcnt vmcnt(2)
    v_cmp_ne_u32 vcc, 1, v7
    s_nop 0
    s_cmp_eq_u64 vcc, 0
    s_cbranch_scc1 SY2_got
    buffer_load_dword v7, v1, s[24:27], s39 offen sc1
    s_add_u32 s11, s11, 1
    s_cmp_lt_u32 s11, 0x8000
    s_cbranch_scc1 SY2_poll
SY2_got:
    s_mov_b64 exec, -1
SY2_e:
    s_barrier
    s_add_u32 m0, s33, 0
    s_nop 0
    buffer_load_dwordx4 v15, s[24:27], s43 offen offset:0 sc1 lds
    buffer_load_dwordx4 v15, s[24:27], s43 offen offset:1024 sc1 lds
    buffer_load_dwordx4 v15, s[24:27], s43 offen offset:2048 sc1 lds
    buffer_load_dwordx4 v15, s[24:27], s43 offen offset:3072 sc1 lds
    s_add_u32 s43, s43, 16384
    s_add_u32 m0, s33, 40960
    s_nop 0
    buffer_load_dwordx4 v15, s[24:27], s43 offen offset:0 sc1 lds
    buffer_load_dwordx4 v15, s[24:27], s43 offen offset:1024 sc1 lds
    buffer_load_dwordx4 v15, s[24:27], s43 offen offset:2048 sc1 lds
    buffer_load_dwordx4 v15, s[24:27], s43 offen offset:3072 sc1 lds
    s_add_u32 s43, s43, 16384
    s_waitcnt lgkmcnt(0)
    s_waitcnt vmcnt(4)
    s_barrier
    s_add_u32 m0, s33, 81920
    s_nop 0
    buffer_load_dwordx4 v15, s[24:27], s43 offen offset:0 sc1 lds
    buffer_load_dwordx4 v15, s[24:27], s43 offen offset:1024 sc1 lds
    buffer_load_dwordx4 v15, s[24:27], s43 offen offset:2048 sc1 lds
    buffer_load_dwordx4 v15, s[24:27], s43 offen offset:3072 sc1 lds
    s_add_u32 s43, s43, 16384
    s_lshl_b32 s10, s54, 14
    s_lshl_b32 s36, s48, 12
    s_add_u32 s10, s10, s36
    s_add_u32 s10, s10, 19988480
    v_lshlrev_b32 v8, 3, v0
    buffer_load_dwordx2 v[192:193], v8, s[24:27], s10 offen offset:0 sc1
    buffer_load_dwordx2 v[194:195], v8, s[24:27], s10 offen offset:512 sc1
    buffer_load_dwordx2 v[196:197], v8, s[24:27], s10 offen offset:1024 sc1
    buffer_load_dwordx2 v[198:199], v8, s[24:27], s10 offen offset:1536 sc1
    buffer_load_dwordx2 v[200:201], v8, s[24:27], s10 offen offset:2048 sc1
    buffer_load_dwordx2 v[202:203], v8, s[24:27], s10 offen offset:2560 sc1
    buffer_load_dwordx2 v[204:205], v8, s[24:27], s10 offen offset:3072 sc1
    buffer_load_dwordx2 v[206:207], v8, s[24:27], s10 offen offset:3584 sc1
    s_waitcnt vmcnt(12)
    s_barrier
    s_add_u32 m0, s33, 0
    s_nop 0
    buffer_load_dwordx4 v15, s[24:27], s43 offen offset:0 sc1 lds
    buffer_load_dwordx4 v15, s[24:27], s43 offen offset:1024 sc1 lds
    buffer_load_dwordx4 v15, s[24:27], s43 offen offset:2048 sc1 lds
    buffer_load_dwordx4 v15, s[24:27], s43 offen offset:3072 sc1 lds
    s_add_u32 s43, s43, 16384
    s_add_u32 m0, s33, 4096
    s_add_u32 s37, s42, 4096
    buffer_load_dwordx4 v15, s[24:27], s42 offen offset:0 sc1 lds
    buffer_load_dwordx4 v15, s[24:27], s42 offen offset:1024 sc1 lds
    buffer_load_dwordx4 v15, s[24:27], s42 offen offset:2048 sc1 lds
    buffer_load_dwordx4 v15, s[24:27], s42 offen offset:3072 sc1 lds
    s_add_u32 m0, s33, 8192
    s_add_u32 s42, s42, 393216
    buffer_load_dwordx4 v15, s[24:27], s37 offen offset:0 sc1 lds
    buffer_load_dwordx4 v15, s[24:27], s37 offen offset:1024 sc1 lds
    s_waitcnt vmcnt(18)
    s_barrier
    s_add_u32 m0, s33, 40960
    s_nop 0
    buffer_load_dwordx4 v15, s[24:27], s43 offen offset:0 sc1 lds
    buffer_load_dwordx4 v15, s[24:27], s43 offen offset:1024 sc1 lds
    buffer_load_dwordx4 v15, s[24:27], s43 offen offset:2048 sc1 lds
    buffer_load_dwordx4 v15, s[24:27], s43 offen offset:3072 sc1 lds
    s_add_u32 s43, s43, 16384
    s_add_u32 m0, s33, 45056
    s_add_u32 s37, s42, 4096
    buffer_load_dwordx4 v15, s[24:27], s42 offen offset:0 sc1 lds
    buffer_load_dwordx4 v15, s[24:27], s42 offen offset:1024 sc1 lds
    buffer_load_dwordx4 v15, s[24:27], s42 offen offset:2048 sc1 lds
    buffer_load_dwordx4 v15, s[24:27], s42 offen offset:3072 sc1 lds
    s_add_u32 m0, s33, 49152
    s_add_u32 s42, s42, 393216
    buffer_load_dwordx4 v15, s[24:27], s37 offen offset:0 sc1 lds
    buffer_load_dwordx4 v15, s[24:27], s37 offen offset:1024 sc1 lds
    s_waitcnt vmcnt(10)
    s_barrier
    s_add_u32 m0, s33, 81920
    s_nop 0
    buffer_load_dwordx4 v15, s[24:27], s43 offen offset:0 sc1 lds
    buffer_load_dwordx4 v15, s[24:27], s43 offen offset:1024 sc1 lds
    buffer_load_dwordx4 v15, s[24:27], s43 offen offset:2048 sc1 lds
    buffer_load_dwordx4 v15, s[24:27], s43 offen offset:3072 sc1 lds
    s_add_u32 s43, s43, 16384
    s_add_u32 m0, s33, 86016
    s_add_u32 s37, s42, 4096
    buffer_load_dwordx4 v15, s[24:27], s42 offen offset:0 sc1 lds
    buffer_load_dwordx4 v15, s[24:27], s42 offen offset:1024 sc1 lds
    buffer_load_dwordx4 v15, s[24:27], s42 offen offset:2048 sc1 lds
    buffer_load_dwordx4 v15, s[24:27], s42 offen offset:3072 sc1 lds
    s_add_u32 m0, s33, 90112
    s_add_u32 s42, s42, 393216
    buffer_load_dwordx4 v15, s[24:27], s37 offen offset:0 sc1 lds
    buffer_load_dwordx4 v15, s[24:27], s37 offen offset:1024 sc1 lds
    s_waitcnt vmcnt(10)
    s_barrier
    s_add_u32 m0, s33, 0
    s_nop 0
    buffer_load_dwordx4 v15, s[24:27], s43 offen offset:0 sc1 lds
    buffer_load_dwordx4 v15, s[24:27], s43 offen offset:1024 sc1 lds
    buffer_load_dwordx4 v15, s[24:27], s43 offen offset:2048 sc1 lds
    buffer_load_dwordx4 v15, s[24:27], s43 offen offset:3072 sc1 lds
    s_add_u32 s43, s43, 16384
    s_add_u32 m0, s33, 4096
    s_add_u32 s37, s42, 4096
    buffer_load_dwordx4 v15, s[24:27], s42 offen offset:0 sc1 lds
    buffer_load_dwordx4 v15, s[24:27], s42 offen offset:1024 sc1 lds
    buffer_load_dwordx4 v15, s[24:27], s42 offen offset:2048 sc1 lds
    buffer_load_dwordx4 v15, s[24:27], s42 offen offset:3072 sc1 lds
    s_add_u32 m0, s33, 8192
    s_add_u32 s42, s42, 393216
    buffer_load_dwordx4 v15, s[24:27], s37 offen offset:0 sc1 lds
    buffer_load_dwordx4 v15, s[24:27], s37 offen offset:1024 sc1 lds
    s_waitcnt vmcnt(10)
    s_barrier
    s_add_u32 m0, s33, 40960
    s_nop 0
    buffer_load_dwordx4 v15, s[24:27], s43 offen offset:0 sc1 lds
    buffer_load_dwordx4 v15, s[24:27], s43 offen offset:1024 sc1 lds
    buffer_load_dwordx4 v15, s[24:27], s43 offen offset:2048 sc1 lds
    buffer_load_dwordx4 v15, s[24:27], s43 offen offset:3072 sc1 lds
    s_add_u32 s43, s43, 16384
    s_add_u32 m0, s33, 45056
    s_add_u32 s37, s42, 4096
    buffer_load_dwordx4 v15, s[24:27], s42 offen offset:0 sc1 lds
    buffer_load_dwordx4 v15, s[24:27], s42 offen offset:1024 sc1 lds
    buffer_load_dwordx4 v15, s[24:27], s42 offen offset:2048 sc1 lds
    buffer_load_dwordx4 v15, s[24:27], s42 offen offset:3072 sc1 lds
    s_add_u32 m0, s33, 49152
    s_add_u32 s42, s42, 393216
    buffer_load_dwordx4 v15, s[24:27], s37 offen offset:0 sc1 lds
    buffer_load_dwordx4 v15, s[24:27], s37 offen offset:1024 sc1 lds
    s_waitcnt vmcnt(10)
    s_barrier
    s_add_u32 m0, s33, 81920
    s_nop 0
    buffer_load_dwordx4 v15, s[24:27], s43 offen offset:0 sc1 lds
    buffer_load_dwordx4 v15, s[24:27], s43 offen offset:1024 sc1 lds
    buffer_load_dwordx4 v15, s[24:27], s43 offen offset:2048 sc1 lds
    buffer_load_dwordx4 v15, s[24:27], s43 offen offset:3072 sc1 lds
    s_add_u32 s43, s43, 16384
    s_add_u32 m0, s33, 86016
    s_add_u32 s37, s42, 4096
    buffer_load_dwordx4 v15, s[24:27], s42 offen offset:0 sc1 lds
    buffer_load_dwordx4 v15, s[24:27], s42 offen offset:1024 sc1 lds
    buffer_load_dwordx4 v15, s[24:27], s42 offen offset:2048 sc1 lds
    buffer_load_dwordx4 v15, s[24:27], s42 offen offset:3072 sc1 lds
    s_add_u32 m0, s33, 90112
    s_add_u32 s42, s42, 393216
    buffer_load_dwordx4 v15, s[24:27], s37 offen offset:0 sc1 lds
    buffer_load_dwordx4 v15, s[24:27], s37 offen offset:1024 sc1 lds
    s_waitcnt vmcnt(10)
    s_barrier
    s_add_u32 m0, s33, 0
    s_nop 0
    buffer_load_dwordx4 v15, s[24:27], s43 offen offset:0 sc1 lds
    buffer_load_dwordx4 v15, s[24:27], s43 offen offset:1024 sc1 lds
    buffer_load_dwordx4 v15, s[24:27], s43 offen offset:2048 sc1 lds
    buffer_load_dwordx4 v15, s[24:27], s43 offen offset:3072 sc1 lds
    s_add_u32 s43, s43, 16384
    s_add_u32 m0, s33, 4096
    s_add_u32 s37, s42, 4096
    buffer_load_dwordx4 v15, s[24:27], s42 offen offset:0 sc1 lds
    buffer_load_dwordx4 v15, s[24:27], s42 offen offset:1024 sc1 lds
    buffer_load_dwordx4 v15, s[24:27], s42 offen offset:2048 sc1 lds
    buffer_load_dwordx4 v15, s[24:27], s42 offen offset:3072 sc1 lds
    s_add_u32 m0, s33, 8192
    s_add_u32 s42, s42, 393216
    buffer_load_dwordx4 v15, s[24:27], s37 offen offset:0 sc1 lds
    buffer_load_dwordx4 v15, s[24:27], s37 offen offset:1024 sc1 lds
    s_waitcnt vmcnt(10)
    s_barrier
    s_waitcnt vmcnt(63)
    v_add_f32 v192, v192, v194
    v_add_f32 v193, v193, v195
    v_add_f32 v196, v196, v198
    v_add_f32 v197, v197, v199
    v_add_f32 v192, v192, v196
    v_add_f32 v193, v193, v197
    v_add_f32 v200, v200, v202
    v_add_f32 v201, v201, v203
    v_add_f32 v204, v204, v206
    v_add_f32 v205, v205, v207
    v_add_f32 v200, v200, v204
    v_add_f32 v201, v201, v205
    v_mov_b32 v194, v192
    v_mov_b32 v195, v193
    v_mov_b32 v202, v200
    v_mov_b32 v203, v201
    s_nop 0
    v_permlane16_swap_b32 v192, v194
    v_permlane16_swap_b32 v193, v195
    v_permlane16_swap_b32 v200, v202
    v_permlane16_swap_b32 v201, v203
    s_nop 0
    v_add_f32 v192, v192, v194
    v_add_f32 v193, v193, v195
    v_add_f32 v200, v200, v202
    v_add_f32 v201, v201, v203
    v_mov_b32 v194, v192
    v_mov_b32 v195, v193
    v_mov_b32 v202, v200
    v_mov_b32 v203, v201
    s_nop 0
    v_permlane32_swap_b32 v192, v194
    v_permlane32_swap_b32 v193, v195
    v_permlane32_swap_b32 v200, v202
    v_permlane32_swap_b32 v201, v203
    s_nop 0
    v_add_f32 v192, v192, v194
    v_add_f32 v193, v193, v195
    v_add_f32 v200, v200, v202
    v_add_f32 v201, v201, v203
    v_mul_f32 v196, 0xbacccccd, v192
    v_mul_f32 v193, 0x3acccccd, v193
    v_fma_f32 v193, -v196, v196, v193
    v_max_f32 v193, 0, v193
    v_add_f32 v197, 0x3727c5ac, v193
    v_rsq_f32 v198, v197
    v_mul_f32 v204, 0xbacccccd, v200
    v_mul_f32 v201, 0x3acccccd, v201
    v_fma_f32 v201, -v204, v204, v201
    v_max_f32 v201, 0, v201
    v_add_f32 v205, 0x3727c5ac, v201
    v_rsq_f32 v206, v205
    v_and_b32 v10, 15, v0
    v_lshlrev_b32 v10, 4, v10
    s_lshl_b32 s10, s48, 9
    s_add_u32 s10, s10, 123904
    v_add_u32 v10, s10, v10
    v_mul_f32 v199, v198, v198
    v_mul_f32 v198, 0xc0135761, v198
    v_mul_f32 v199, v199, v198
    v_mul_f32 v199, 0x3d372713, v199
    ds_write_b128 v10, v[196:199] offset:0
    v_mul_f32 v207, v206, v206
    v_mul_f32 v206, 0xc0135761, v206
    v_mul_f32 v207, v207, v206
    v_mul_f32 v207, 0x3d372713, v207
    ds_write_b128 v10, v[204:207] offset:256
    s_cmp_lg_u32 s28, 4
    s_cbranch_scc1 SV_ncs2
    ds_read_b128 v[144:147], v4 offset:3072
    s_waitcnt lgkmcnt(0)
    v_add_f32 v140, v140, v144
    v_add_f32 v141, v141, v145
    v_add_f32 v142, v142, v146
    v_add_f32 v143, v143, v147
    ds_write_b128 v4, v[140:143]
SV_ncs2:
    s_waitcnt lgkmcnt(0)
    s_waitcnt vmcnt(0)
    s_barrier
    s_and_b32 s11, s28, 1
    s_mul_i32 s33, s11, 5120
    v_add_u32 v3, s33, v15
    v_add_u32 v5, 61440, v3
    s_cmp_ge_u32 s28, 6
    s_cbranch_scc1 SV_dn_w
    s_barrier
    ds_write_b128 v5, v[16:19] offset:0
    ds_write_b128 v5, v[20:23] offset:1024
    ds_write_b128 v5, v[24:27] offset:2048
    ds_write_b128 v5, v[28:31] offset:3072
    ds_write_b128 v5, v[32:35] offset:4096
    ds_write_b128 v5, v[36:39] offset:10240
    ds_write_b128 v5, v[40:43] offset:11264
    ds_write_b128 v5, v[44:47] offset:12288
    ds_write_b128 v5, v[48:51] offset:13312
    ds_write_b128 v5, v[52:55] offset:14336
    ds_write_b128 v5, v[56:59] offset:20480
    ds_write_b128 v5, v[60:63] offset:21504
    ds_write_b128 v5, v[64:67] offset:22528
    ds_write_b128 v5, v[68:71] offset:23552
    ds_write_b128 v5, v[72:75] offset:24576
    ds_write_b128 v5, v[76:79] offset:30720
    ds_write_b128 v5, v[80:83] offset:31744
    ds_write_b128 v5, v[84:87] offset:32768
    ds_write_b128 v5, v[88:91] offset:33792
    ds_write_b128 v5, v[92:95] offset:34816
    ds_write_b128 v5, v[96:99] offset:40960
    ds_write_b128 v5, v[100:103] offset:41984
    ds_write_b128 v5, v[104:107] offset:43008
    ds_write_b128 v5, v[108:111] offset:44032
    ds_write_b128 v5, v[112:115] offset:45056
    ds_write_b128 v5, v[116:119] offset:51200
    ds_write_b128 v5, v[120:123] offset:52224
    ds_write_b128 v5, v[124:127] offset:53248
    ds_write_b128 v5, v[128:131] offset:54272
    ds_write_b128 v5, v[132:135] offset:55296
    s_waitcnt lgkmcnt(0)
    s_mul_i32 s39, s54, 512
    s_add_u32 s39, s39, 27082752
    s_lshl_b32 s38, s55, 2
    s_add_u32 s38, s38, s39
    v_lshlrev_b32 v9, 7, v0
    v_mov_b32 v8, 1
    s_lshl_b32 s10, s49, 7
    s_add_u32 s39, s39, s10
    v_lshlrev_b32 v1, 2, v0
    s_cmp_lg_u32 s28, 4
    s_barrier
    s_cbranch_scc1 SY3_e
    s_mov_b64 exec, 15
    buffer_store_dword v8, v9, s[24:27], s38 offen sc1
    s_mov_b32 exec_lo, 0xffff
    s_mov_b32 s11, 0
    buffer_load_dword v2, v1, s[24:27], s39 offen sc1
    s_sleep 3
    buffer_load_dword v6, v1, s[24:27], s39 offen sc1
    s_sleep 3
    buffer_load_dword v7, v1, s[24:27], s39 offen sc1
SY3_poll:
    s_waitcnt vmcnt(2)
    v_cmp_ne_u32 vcc, 1, v2
    s_nop 0
    s_cmp_eq_u64 vcc, 0
    s_cbranch_scc1 SY3_got
    buffer_load_dword v2, v1, s[24:27], s39 offen sc1
    s_waitcnt vmcnt(2)
    v_cmp_ne_u32 vcc, 1, v6
    s_nop 0
    s_cmp_eq_u64 vcc, 0
    s_cbranch_scc1 SY3_got
    buffer_load_dword v6, v1, s[24:27], s39 offen sc1
    s_waitcnt vmcnt(2)
    v_cmp_ne_u32 vcc, 1, v7
    s_nop 0
    s_cmp_eq_u64 vcc, 0
    s_cbranch_scc1 SY3_got
    buffer_load_dword v7, v1, s[24:27], s39 offen sc1
    s_add_u32 s11, s11, 1
    s_cmp_lt_u32 s11, 0x8000
    s_cbranch_scc1 SY3_poll
SY3_got:
    s_mov_b64 exec, -1
SY3_e:
    s_barrier
    s_endpgm
SV_dn_w:
    s_add_u32 s10, s59, 4096
    buffer_load_dwordx4 v[176:179], v15, s[24:27], s59 offen offset:0 sc1
    buffer_load_dwordx4 v[180:183], v15, s[24:27], s59 offen offset:1024 sc1
    buffer_load_dwordx4 v[184:187], v15, s[24:27], s59 offen offset:2048 sc1
    buffer_load_dwordx4 v[188:191], v15, s[24:27], s59 offen offset:3072 sc1
    buffer_load_dwordx4 v[192:195], v15, s[24:27], s10 offen offset:0 sc1
    s_add_u32 s59, s59, 81920
    s_add_u32 s10, s59, 4096
    buffer_load_dwordx4 v[196:199], v15, s[24:27], s59 offen offset:0 sc1
    buffer_load_dwordx4 v[200:203], v15, s[24:27], s59 offen offset:1024 sc1
    buffer_load_dwordx4 v[204:207], v15, s[24:27], s59 offen offset:2048 sc1
    buffer_load_dwordx4 v[208:211], v15, s[24:27], s59 offen offset:3072 sc1
    buffer_load_dwordx4 v[212:215], v15, s[24:27], s10 offen offset:0 sc1
    s_add_u32 s59, s59, 81920
    s_add_u32 s10, s59, 4096
    buffer_load_dwordx4 v[216:219], v15, s[24:27], s59 offen offset:0 sc1
    buffer_load_dwordx4 v[220:223], v15, s[24:27], s59 offen offset:1024 sc1
    buffer_load_dwordx4 v[224:227], v15, s[24:27], s59 offen offset:2048 sc1
    buffer_load_dwordx4 v[228:231], v15, s[24:27], s59 offen offset:3072 sc1
    buffer_load_dwordx4 v[232:235], v15, s[24:27], s10 offen offset:0 sc1
    s_add_u32 s59, s59, 81920
    s_add_u32 s10, s59, 4096
    buffer_load_dwordx4 v[236:239], v15, s[24:27], s59 offen offset:0 sc1
    buffer_load_dwordx4 v[240:243], v15, s[24:27], s59 offen offset:1024 sc1
    buffer_load_dwordx4 v[244:247], v15, s[24:27], s59 offen offset:2048 sc1
    buffer_load_dwordx4 v[248:251], v15, s[24:27], s59 offen offset:3072 sc1
    buffer_load_dwordx4 v[252:255], v15, s[24:27], s10 offen offset:0 sc1
    s_add_u32 s59, s59, 81920
    s_sub_u32 s42, s59, 1966080
    s_mov_b32 s34, s33
    s_mov_b32 s35, 0
    s_barrier
SV_pw3:
    s_mov_b32 m0, s34
    s_add_u32 s37, s42, 4096
    buffer_load_dwordx4 v15, s[24:27], s42 offen sc1 lds
    buffer_load_dwordx4 v15, s[24:27], s42 offen offset:1024 sc1 lds
    buffer_load_dwordx4 v15, s[24:27], s42 offen offset:2048 sc1 lds
    buffer_load_dwordx4 v15, s[24:27], s42 offen offset:3072 sc1 lds
    s_add_u32 m0, s34, 4096
    s_add_u32 s42, s42, 81920
    buffer_load_dwordx4 v15, s[24:27], s37 offen sc1 lds
    s_add_u32 s34, s34, 10240
    s_add_u32 s35, s35, 1
    s_cmp_lt_u32 s35, 6
    s_cbranch_scc1 SV_pw3
    s_barrier
    s_waitcnt vmcnt(0)
    s_barrier
    s_waitcnt lgkmcnt(7)
    s_barrier
    ds_write_b128 v3, v[16:19] offset:0
    ds_write_b128 v3, v[20:23] offset:1024
    ds_write_b128 v3, v[24:27] offset:2048
    ds_write_b128 v3, v[28:31] offset:3072
    ds_write_b128 v3, v[32:35] offset:4096
    ds_write_b128 v3, v[36:39] offset:10240
    ds_write_b128 v3, v[40:43] offset:11264
    s_waitcnt lgkmcnt(7)
    s_barrier
    ds_write_b128 v3, v[44:47] offset:12288
    ds_write_b128 v3, v[48:51] offset:13312
    ds_write_b128 v3, v[52:55] offset:14336
    ds_write_b128 v3, v[56:59] offset:20480
    ds_write_b128 v3, v[60:63] offset:21504
    ds_write_b128 v3, v[64:67] offset:22528
    ds_write_b128 v3, v[68:71] offset:23552
    s_waitcnt lgkmcnt(7)
    s_barrier
    ds_write_b128 v3, v[72:75] offset:24576
    ds_write_b128 v3, v[76:79] offset:30720
    ds_write_b128 v3, v[80:83] offset:31744
    ds_write_b128 v3, v[84:87] offset:32768
    ds_write_b128 v3, v[88:91] offset:33792
    ds_write_b128 v3, v[92:95] offset:34816
    ds_write_b128 v3, v[96:99] offset:40960
    s_waitcnt lgkmcnt(7)
    s_barrier
    ds_write_b128 v3, v[100:103] offset:41984
    ds_write_b128 v3, v[104:107] offset:43008
    ds_write_b128 v3, v[108:111] offset:44032
    ds_write_b128 v3, v[112:115] offset:45056
    ds_write_b128 v3, v[116:119] offset:51200
    ds_write_b128 v3, v[120:123] offset:52224
    ds_write_b128 v3, v[124:127] offset:53248
    s_waitcnt lgkmcnt(7)
    s_barrier
    ds_write_b128 v3, v[128:131] offset:54272
    ds_write_b128 v3, v[132:135] offset:55296
    ds_write_b128 v5, v[136:139] offset:0
    ds_write_b128 v5, v[140:143] offset:1024
    ds_write_b128 v5, v[144:147] offset:2048
    ds_write_b128 v5, v[148:151] offset:3072
    ds_write_b128 v5, v[152:155] offset:4096
    s_waitcnt lgkmcnt(7)
    s_barrier
    ds_write_b128 v5, v[156:159] offset:10240
    ds_write_b128 v5, v[160:163] offset:11264
    ds_write_b128 v5, v[164:167] offset:12288
    ds_write_b128 v5, v[168:171] offset:13312
    ds_write_b128 v5, v[172:175] offset:14336
    ds_write_b128 v5, v[176:179] offset:20480
    ds_write_b128 v5, v[180:183] offset:21504
    s_waitcnt lgkmcnt(7)
    s_barrier
    ds_write_b128 v5, v[184:187] offset:22528
    ds_write_b128 v5, v[188:191] offset:23552
    ds_write_b128 v5, v[192:195] offset:24576
    ds_write_b128 v5, v[196:199] offset:30720
    ds_write_b128 v5, v[200:203] offset:31744
    ds_write_b128 v5, v[204:207] offset:32768
    ds_write_b128 v5, v[208:211] offset:33792
    s_waitcnt lgkmcnt(7)
    s_barrier
    ds_write_b128 v5, v[212:215] offset:34816
    ds_write_b128 v5, v[216:219] offset:40960
    ds_write_b128 v5, v[220:223] offset:41984
    ds_write_b128 v5, v[224:227] offset:43008
    ds_write_b128 v5, v[228:231] offset:44032
    ds_write_b128 v5, v[232:235] offset:45056
    ds_write_b128 v5, v[236:239] offset:51200
    s_waitcnt lgkmcnt(7)
    s_barrier
    ds_write_b128 v5, v[240:243] offset:52224
    ds_write_b128 v5, v[244:247] offset:53248
    ds_write_b128 v5, v[248:251] offset:54272
    ds_write_b128 v5, v[252:255] offset:55296
    s_waitcnt lgkmcnt(0)
    s_barrier
    s_waitcnt lgkmcnt(0)
    s_barrier
K2_end:
    s_endpgm
CODE_END:
.section .rodata,"a"
.p2align 6
.amdhsa_kernel qkv_kernel
  .amdhsa_next_free_vgpr 200
  .amdhsa_next_free_sgpr 64
  .amdhsa_accum_offset 200
  .amdhsa_group_segment_fixed_size 0
  .amdhsa_kernarg_size 80
  .amdhsa_user_sgpr_count 2
  .amdhsa_user_sgpr_kernarg_segment_ptr 1
  .amdhsa_system_sgpr_workgroup_id_x 1
.end_amdhsa_kernel
.p2align 6
.amdhsa_kernel mega_kernel
  .amdhsa_next_free_vgpr 256
  .amdhsa_next_free_sgpr 64
  .amdhsa_accum_offset 256
  .amdhsa_group_segment_fixed_size 0
  .amdhsa_kernarg_size 80
  .amdhsa_user_sgpr_count 2
  .amdhsa_user_sgpr_kernarg_segment_ptr 1
  .amdhsa_system_sgpr_workgroup_id_x 1
.end_amdhsa_kernel
```
